```python
import torch

def _softmax(x, axis=-1):
    return torch.softmax(x, dim=axis)
def _gelu(x):
    return torch.nn.functional.gelu(x, approximate="tanh")
def _silu(x):
    return torch.nn.functional.silu(x)
def _sigmoid(x):
    return torch.sigmoid(x)
def _layernorm(x, axis=-1, eps=1e-5):
    m = x.mean(dim=axis, keepdim=True)
    v = x.var(dim=axis, keepdim=True, unbiased=False)
    return (x - m) / torch.sqrt(v + eps)
def _scatter_add(tgt, idx, src, axis=0):
    return tgt.clone().index_add_(axis, idx, src)
def _segment_sum(src, seg, n):
    out = torch.zeros((n,) + src.shape[1:], dtype=src.dtype)
    return out.index_add_(0, seg, src)
def _pad(x, pw):
    flat = tuple(v for pair in reversed(pw) for v in pair)
    return torch.nn.functional.pad(x, flat)

kernel_name = 'interleave_layers__spectral_fnet__swiglu_ffn__prompt'

def setup_inputs():

    _w = (lambda a: (lambda t: t.to(torch.bfloat16) if t.is_floating_point() else t)(torch.as_tensor(a)))
    def _A_setup():
        B, S, D = 1, 2048, 512
        ns = torch.arange(S)[:, None] * torch.arange(S)[None, :]
        nd = torch.arange(D)[:, None] * torch.arange(D)[None, :]
        Ws_re = torch.cos(-2.0 * torch.pi * ns / S).to(float)
        Ws_im = torch.sin(-2.0 * torch.pi * ns / S).to(float)
        Wd_re = torch.cos(-2.0 * torch.pi * nd / D).to(float)
        Wd_im = torch.sin(-2.0 * torch.pi * nd / D).to(float)
        return {
            "x": _w((lambda *s: torch.randn(*s, dtype=torch.bfloat16) * 0.05)(B, S, D)),
            "dft_seq_re": _w(Ws_re),
            "dft_seq_im": _w(Ws_im),
            "dft_hid_re": _w(Wd_re),
            "dft_hid_im": _w(Wd_im),
        }
    _A_in = _A_setup()

    def _B_setup():
        B, S, D, F = 1, 2048, 512, 1792
        return {
            "x": _w((lambda *s: torch.randn(*s, dtype=torch.bfloat16) * 0.05)(B, S, D)),
            "w_gate": _w((lambda *s: torch.randn(*s, dtype=torch.bfloat16) * 0.4)(D, F)),
            "w_up": _w((lambda *s: torch.randn(*s, dtype=torch.bfloat16) * 0.4)(D, F)),
            "w_down": _w((lambda *s: torch.randn(*s, dtype=torch.bfloat16) * 0.4)(F, D)),
        }
    _B_in = _B_setup()

    return {
        "A_x": _A_in["x"],
        "A_dft_seq_re": _A_in["dft_seq_re"],
        "A_dft_seq_im": _A_in["dft_seq_im"],
        "A_dft_hid_re": _A_in["dft_hid_re"],
        "A_dft_hid_im": _A_in["dft_hid_im"],
        "B_x": _B_in["x"],
        "B_w_gate": _B_in["w_gate"],
        "B_w_up": _B_in["w_up"],
        "B_w_down": _B_in["w_down"],
    }

def reference(A_x, A_dft_seq_re, A_dft_seq_im, A_dft_hid_re, A_dft_hid_im, B_x, B_w_gate, B_w_up, B_w_down):
    def _A_ref(x, dft_seq_re, dft_seq_im, dft_hid_re, dft_hid_im):
        a = torch.einsum("bsd,ed->bse", x, dft_hid_re)
        b = torch.einsum("bsd,ed->bse", x, dft_hid_im)
        y = torch.einsum("ts,bse->bte", dft_seq_re, a) - torch.einsum("ts,bse->bte", dft_seq_im, b)
        return y

    def _B_ref(x, w_gate, w_up, w_down):
        g = _silu(x @ w_gate)
        u = x @ w_up
        return (g * u) @ w_down

    x = A_x
    x = x + _A_ref(_layernorm(x, axis=-1), A_dft_seq_re, A_dft_seq_im, A_dft_hid_re, A_dft_hid_im)
    x = x + _B_ref(_layernorm(x, axis=-1), B_w_gate, B_w_up, B_w_down)
    x = x + _A_ref(_layernorm(x, axis=-1), A_dft_seq_re, A_dft_seq_im, A_dft_hid_re, A_dft_hid_im)
    x = x + _B_ref(_layernorm(x, axis=-1), B_w_gate, B_w_up, B_w_down)
    return x
```

```asm
; @launch grid=(256,1,1) block=(256,1,1) lds=163840
.amdgcn_target "amdgcn-amd-amdhsa--gfx950"
.text
.globl interleave_layers__spectral_fnet__swiglu_ffn__prompt_kernel
.p2align 8
.type interleave_layers__spectral_fnet__swiglu_ffn__prompt_kernel,@function
interleave_layers__spectral_fnet__swiglu_ffn__prompt_kernel:
    s_cmp_ge_u32 s2, 256
    s_cbranch_scc1 k_exit
    s_load_dwordx2 s[4:5], s[0:1], 88
    s_load_dwordx2 s[6:7], s[0:1], 0
    s_load_dwordx4 s[60:63], s[0:1], 24
    s_load_dwordx4 s[64:67], s[0:1], 48
    s_load_dwordx4 s[68:71], s[0:1], 64
    s_load_dwordx2 s[96:97], s[0:1], 80
    v_lshrrev_b32 v1, 6, v0
    v_and_b32 v0, 63, v0
    v_readfirstlane_b32 s10, v1
    v_lshlrev_b32 v1, 4, v0
    s_and_b32 s11, s2, 7
    s_lshr_b32 s12, s2, 3
    s_mov_b32 s73, 0
    s_getpc_b64 s[54:55]
k_pc:
    s_sub_u32 s54, s54, k_pc-interleave_layers__spectral_fnet__swiglu_ffn__prompt_kernel
    s_subb_u32 s55, s55, 0
    v_lshlrev_b32 v2, 7, v0
    s_lshl_b32 s56, s10, 13
    v_add_u32 v2, s56, v2
    v_cmp_gt_u32 vcc, k_end-interleave_layers__spectral_fnet__swiglu_ffn__prompt_kernel, v2
    s_and_saveexec_b64 s[56:57], vcc
    s_cbranch_execz k_pf_skip
    global_load_dword v254, v2, s[54:55]
k_pf_skip:
    s_mov_b64 exec, -1
    s_and_b32 s13, s12, 7
    s_lshr_b32 s14, s12, 3
    s_and_b32 s50, s10, 1
    s_lshr_b32 s51, s10, 1
    v_lshrrev_b32 v2, 3, v0
    v_and_b32 v3, 7, v0
    s_lshl_b32 s54, s14, 1
    s_add_u32 s54, s54, s50
    s_lshl_b32 s55, s54, 5
    s_add_u32 s55, s55, s11
    s_lshl_b32 s57, s51, 4
    v_add_u32 v4, 0, v2
    v_add_u32 v4, s57, v4
    v_lshrrev_b32 v6, 4, v4
    v_lshlrev_b32 v6, 2, v6
    v_and_b32 v5, 3, v4
    v_add_u32 v5, v5, v6
    v_lshlrev_b32 v5, 8, v5
    v_bfe_u32 v6, v4, 2, 2
    v_lshl_add_u32 v5, v6, 3, v5
    v_add_u32 v5, s55, v5
    v_bfe_u32 v6, v4, 1, 3
    v_xor_b32 v6, v6, v3
    v_lshlrev_b32 v6, 4, v6
    v_lshl_add_u32 v8, v5, 10, v6
    v_add_u32 v4, 8, v2
    v_add_u32 v4, s57, v4
    v_lshrrev_b32 v6, 4, v4
    v_lshlrev_b32 v6, 2, v6
    v_and_b32 v5, 3, v4
    v_add_u32 v5, v5, v6
    v_lshlrev_b32 v5, 8, v5
    v_bfe_u32 v6, v4, 2, 2
    v_lshl_add_u32 v5, v6, 3, v5
    v_add_u32 v5, s55, v5
    v_bfe_u32 v6, v4, 1, 3
    v_xor_b32 v6, v6, v3
    v_lshlrev_b32 v6, 4, v6
    v_lshl_add_u32 v9, v5, 10, v6
    s_lshl_b32 s54, s11, 3
    s_lshl_b32 s55, s14, 1
    s_add_u32 s54, s54, s55
    s_add_u32 s54, s54, s50
    s_and_b32 s55, s54, 7
    s_lshl_b32 s55, s55, 5
    s_add_u32 s55, s55, s11
    v_and_b32 v32, 31, v0
    v_lshrrev_b32 v33, 4, v32
    v_lshlrev_b32 v33, 2, v33
    v_and_b32 v28, 3, v32
    v_add_u32 v28, v28, v33
    v_lshlrev_b32 v28, 8, v28
    v_bfe_u32 v33, v32, 2, 2
    v_lshl_add_u32 v28, v33, 3, v28
    v_add_u32 v28, s55, v28
    v_cvt_f32_u32 v28, v28
    v_mul_f32 v28, 0x3a000000, v28
    v_mul_f32 v29, 0x41000000, v28
    v_and_b32 v30, 32, v0
    s_lshl_b32 s55, s51, 7
    v_add_u32 v30, s55, v30
    v_cvt_f32_u32 v30, v30
    v_add_f32 v31, 0x42800000, v30
    v_mul_f32 v30, v30, v28
    v_mul_f32 v31, v31, v28
    s_waitcnt lgkmcnt(0)
    s_cmp_ge_u32 s2, 8
    s_cbranch_scc1 z_1
    s_cmp_lg_u32 s10, 3
    s_cbranch_scc1 z_1
    s_mul_i32 s54, s2, 21504
    s_add_u32 s54, s54, 0x2500000
    v_add_u32 v44, s54, v1
    v_mov_b32 v46, 0
    v_mov_b32 v47, 0
    v_mov_b32 v48, 0
    v_mov_b32 v49, 0
    global_store_dwordx4 v44, v[46:49], s[4:5] offset:0 sc1
    global_store_dwordx4 v44, v[46:49], s[4:5] offset:1024 sc1
    global_store_dwordx4 v44, v[46:49], s[4:5] offset:2048 sc1
    global_store_dwordx4 v44, v[46:49], s[4:5] offset:3072 sc1
    s_nop 1
    v_add_u32 v44, 0x1000, v44
    global_store_dwordx4 v44, v[46:49], s[4:5] offset:0 sc1
    global_store_dwordx4 v44, v[46:49], s[4:5] offset:1024 sc1
    global_store_dwordx4 v44, v[46:49], s[4:5] offset:2048 sc1
    global_store_dwordx4 v44, v[46:49], s[4:5] offset:3072 sc1
    s_nop 1
    v_add_u32 v44, 0x1000, v44
    global_store_dwordx4 v44, v[46:49], s[4:5] offset:0 sc1
    global_store_dwordx4 v44, v[46:49], s[4:5] offset:1024 sc1
    global_store_dwordx4 v44, v[46:49], s[4:5] offset:2048 sc1
    global_store_dwordx4 v44, v[46:49], s[4:5] offset:3072 sc1
    s_nop 1
    v_add_u32 v44, 0x1000, v44
    global_store_dwordx4 v44, v[46:49], s[4:5] offset:0 sc1
    global_store_dwordx4 v44, v[46:49], s[4:5] offset:1024 sc1
    global_store_dwordx4 v44, v[46:49], s[4:5] offset:2048 sc1
    global_store_dwordx4 v44, v[46:49], s[4:5] offset:3072 sc1
    s_nop 1
    v_add_u32 v44, 0x1000, v44
    global_store_dwordx4 v44, v[46:49], s[4:5] offset:0 sc1
    global_store_dwordx4 v44, v[46:49], s[4:5] offset:1024 sc1
    global_store_dwordx4 v44, v[46:49], s[4:5] offset:2048 sc1
    global_store_dwordx4 v44, v[46:49], s[4:5] offset:3072 sc1
    s_nop 1
    v_add_u32 v44, 0x1000, v44
    global_store_dwordx4 v44, v[46:49], s[4:5] offset:0 sc1
z_1:
    s_mov_b32 s8, s70
    s_mov_b32 s9, s71
    s_mov_b32 s20, s6
    s_mov_b32 s21, s7
    s_mov_b32 s22, 0x200000
    s_mov_b32 s23, 0x20000
    s_and_b32 s13, s12, 7
    s_lshr_b32 s14, s12, 3
    s_and_b32 s50, s10, 1
    s_lshr_b32 s51, s10, 1
    v_lshrrev_b32 v2, 3, v0
    v_and_b32 v3, 7, v0
    s_lshl_b32 s54, s13, 5
    s_lshl_b32 s55, s50, 4
    s_add_u32 s54, s54, s55
    s_add_u32 s54, s54, 1
    s_cmp_eq_u32 s51, 0
    s_cselect_b32 s16, s60, s62
    s_cselect_b32 s17, s61, s63
    s_mov_b32 s18, 0x80000
    s_mov_b32 s19, 0x20000
    v_add_u32 v4, 0, v2
    v_lshrrev_b32 v5, 1, v4
    v_xor_b32 v5, v5, v3
    v_lshlrev_b32 v5, 4, v5
    v_add_u32 v4, s54, v4
    v_lshl_add_u32 v26, v4, 10, v5
    v_add_u32 v4, 8, v2
    v_lshrrev_b32 v5, 1, v4
    v_xor_b32 v5, v5, v3
    v_lshlrev_b32 v5, 4, v5
    v_add_u32 v4, s54, v4
    v_lshl_add_u32 v27, v4, 10, v5
    s_lshl_b32 s33, s50, 12
    s_lshl_b32 s55, s51, 11
    s_add_u32 s33, s33, s55
    s_mov_b32 s35, s33
    s_lshl_b32 s34, s50, 12
    s_lshl_b32 s55, s51, 11
    s_add_u32 s34, s34, s55
    s_add_u32 m0, s34, 0
    s_movk_i32 s32, 0
    buffer_load_dwordx4 v8, s[20:23], s32 offen lds
    s_add_u32 m0, s34, 1024
    s_movk_i32 s32, 0
    buffer_load_dwordx4 v9, s[20:23], s32 offen lds
    s_add_u32 m0, s33, 8192
    s_movk_i32 s32, 0
    buffer_load_dwordx4 v26, s[16:19], s32 offen lds
    s_add_u32 m0, s33, 9216
    s_movk_i32 s32, 0
    buffer_load_dwordx4 v27, s[16:19], s32 offen lds
    v_add_f32 v32, v30, v29
    v_cos_f32 v36, v30
    v_sin_f32 v37, v30
    v_add_f32 v33, v32, v29
    v_cos_f32 v38, v32
    v_sin_f32 v39, v32
    v_add_f32 v34, v33, v29
    v_cos_f32 v40, v33
    v_sin_f32 v41, v33
    v_add_f32 v30, v30, v28
    v_cos_f32 v42, v34
    v_sin_f32 v43, v34
    s_nop 0
    v_cvt_pk_bf16_f32 v184, v36, v37
    v_cvt_pk_bf16_f32 v185, v38, v39
    v_cvt_pk_bf16_f32 v186, v40, v41
    v_cvt_pk_bf16_f32 v187, v42, v43
    v_add_f32 v32, v31, v29
    v_cos_f32 v36, v31
    v_sin_f32 v37, v31
    v_add_f32 v33, v32, v29
    v_cos_f32 v38, v32
    v_sin_f32 v39, v32
    v_add_f32 v34, v33, v29
    v_cos_f32 v40, v33
    v_sin_f32 v41, v33
    v_add_f32 v31, v31, v28
    v_cos_f32 v42, v34
    v_sin_f32 v43, v34
    s_nop 0
    v_cvt_pk_bf16_f32 v188, v36, v37
    v_cvt_pk_bf16_f32 v189, v38, v39
    v_cvt_pk_bf16_f32 v190, v40, v41
    v_cvt_pk_bf16_f32 v191, v42, v43
    s_add_u32 m0, s34, 16384
    s_movk_i32 s32, 128
    buffer_load_dwordx4 v8, s[20:23], s32 offen lds
    s_add_u32 m0, s34, 17408
    s_movk_i32 s32, 128
    buffer_load_dwordx4 v9, s[20:23], s32 offen lds
    s_add_u32 m0, s33, 24576
    s_movk_i32 s32, 128
    buffer_load_dwordx4 v26, s[16:19], s32 offen lds
    s_add_u32 m0, s33, 25600
    s_movk_i32 s32, 128
    buffer_load_dwordx4 v27, s[16:19], s32 offen lds
    v_add_f32 v32, v30, v29
    v_cos_f32 v36, v30
    v_sin_f32 v37, v30
    v_add_f32 v33, v32, v29
    v_cos_f32 v38, v32
    v_sin_f32 v39, v32
    v_add_f32 v34, v33, v29
    v_cos_f32 v40, v33
    v_sin_f32 v41, v33
    v_add_f32 v30, v30, v28
    v_cos_f32 v42, v34
    v_sin_f32 v43, v34
    s_nop 0
    v_cvt_pk_bf16_f32 v192, v36, v37
    v_cvt_pk_bf16_f32 v193, v38, v39
    v_cvt_pk_bf16_f32 v194, v40, v41
    v_cvt_pk_bf16_f32 v195, v42, v43
    v_add_f32 v32, v31, v29
    v_cos_f32 v36, v31
    v_sin_f32 v37, v31
    v_add_f32 v33, v32, v29
    v_cos_f32 v38, v32
    v_sin_f32 v39, v32
    v_add_f32 v34, v33, v29
    v_cos_f32 v40, v33
    v_sin_f32 v41, v33
    v_add_f32 v31, v31, v28
    v_cos_f32 v42, v34
    v_sin_f32 v43, v34
    s_nop 0
    v_cvt_pk_bf16_f32 v196, v36, v37
    v_cvt_pk_bf16_f32 v197, v38, v39
    v_cvt_pk_bf16_f32 v198, v40, v41
    v_cvt_pk_bf16_f32 v199, v42, v43
    s_add_u32 m0, s34, 32768
    s_movk_i32 s32, 256
    buffer_load_dwordx4 v8, s[20:23], s32 offen lds
    s_add_u32 m0, s34, 33792
    s_movk_i32 s32, 256
    buffer_load_dwordx4 v9, s[20:23], s32 offen lds
    s_add_u32 m0, s33, 40960
    s_movk_i32 s32, 256
    buffer_load_dwordx4 v26, s[16:19], s32 offen lds
    s_add_u32 m0, s33, 41984
    s_movk_i32 s32, 256
    buffer_load_dwordx4 v27, s[16:19], s32 offen lds
    v_add_f32 v32, v30, v29
    v_cos_f32 v36, v30
    v_sin_f32 v37, v30
    v_add_f32 v33, v32, v29
    v_cos_f32 v38, v32
    v_sin_f32 v39, v32
    v_add_f32 v34, v33, v29
    v_cos_f32 v40, v33
    v_sin_f32 v41, v33
    v_add_f32 v30, v30, v28
    v_cos_f32 v42, v34
    v_sin_f32 v43, v34
    s_nop 0
    v_cvt_pk_bf16_f32 v200, v36, v37
    v_cvt_pk_bf16_f32 v201, v38, v39
    v_cvt_pk_bf16_f32 v202, v40, v41
    v_cvt_pk_bf16_f32 v203, v42, v43
    v_add_f32 v32, v31, v29
    v_cos_f32 v36, v31
    v_sin_f32 v37, v31
    v_add_f32 v33, v32, v29
    v_cos_f32 v38, v32
    v_sin_f32 v39, v32
    v_add_f32 v34, v33, v29
    v_cos_f32 v40, v33
    v_sin_f32 v41, v33
    v_add_f32 v31, v31, v28
    v_cos_f32 v42, v34
    v_sin_f32 v43, v34
    s_nop 0
    v_cvt_pk_bf16_f32 v204, v36, v37
    v_cvt_pk_bf16_f32 v205, v38, v39
    v_cvt_pk_bf16_f32 v206, v40, v41
    v_cvt_pk_bf16_f32 v207, v42, v43
    s_add_u32 m0, s34, 49152
    s_movk_i32 s32, 384
    buffer_load_dwordx4 v8, s[20:23], s32 offen lds
    s_add_u32 m0, s34, 50176
    s_movk_i32 s32, 384
    buffer_load_dwordx4 v9, s[20:23], s32 offen lds
    s_add_u32 m0, s33, 57344
    s_movk_i32 s32, 384
    buffer_load_dwordx4 v26, s[16:19], s32 offen lds
    s_add_u32 m0, s33, 58368
    s_movk_i32 s32, 384
    buffer_load_dwordx4 v27, s[16:19], s32 offen lds
    v_add_f32 v32, v30, v29
    v_cos_f32 v36, v30
    v_sin_f32 v37, v30
    v_add_f32 v33, v32, v29
    v_cos_f32 v38, v32
    v_sin_f32 v39, v32
    v_add_f32 v34, v33, v29
    v_cos_f32 v40, v33
    v_sin_f32 v41, v33
    v_add_f32 v30, v30, v28
    v_cos_f32 v42, v34
    v_sin_f32 v43, v34
    s_nop 0
    v_cvt_pk_bf16_f32 v208, v36, v37
    v_cvt_pk_bf16_f32 v209, v38, v39
    v_cvt_pk_bf16_f32 v210, v40, v41
    v_cvt_pk_bf16_f32 v211, v42, v43
    v_add_f32 v32, v31, v29
    v_cos_f32 v36, v31
    v_sin_f32 v37, v31
    v_add_f32 v33, v32, v29
    v_cos_f32 v38, v32
    v_sin_f32 v39, v32
    v_add_f32 v34, v33, v29
    v_cos_f32 v40, v33
    v_sin_f32 v41, v33
    v_add_f32 v31, v31, v28
    v_cos_f32 v42, v34
    v_sin_f32 v43, v34
    s_nop 0
    v_cvt_pk_bf16_f32 v212, v36, v37
    v_cvt_pk_bf16_f32 v213, v38, v39
    v_cvt_pk_bf16_f32 v214, v40, v41
    v_cvt_pk_bf16_f32 v215, v42, v43
    s_add_u32 m0, s34, 65536
    s_movk_i32 s32, 512
    buffer_load_dwordx4 v8, s[20:23], s32 offen lds
    s_add_u32 m0, s34, 66560
    s_movk_i32 s32, 512
    buffer_load_dwordx4 v9, s[20:23], s32 offen lds
    s_add_u32 m0, s33, 73728
    s_movk_i32 s32, 512
    buffer_load_dwordx4 v26, s[16:19], s32 offen lds
    s_add_u32 m0, s33, 74752
    s_movk_i32 s32, 512
    buffer_load_dwordx4 v27, s[16:19], s32 offen lds
    v_add_f32 v32, v30, v29
    v_cos_f32 v36, v30
    v_sin_f32 v37, v30
    v_add_f32 v33, v32, v29
    v_cos_f32 v38, v32
    v_sin_f32 v39, v32
    v_add_f32 v34, v33, v29
    v_cos_f32 v40, v33
    v_sin_f32 v41, v33
    v_add_f32 v30, v30, v28
    v_cos_f32 v42, v34
    v_sin_f32 v43, v34
    s_nop 0
    v_cvt_pk_bf16_f32 v216, v36, v37
    v_cvt_pk_bf16_f32 v217, v38, v39
    v_cvt_pk_bf16_f32 v218, v40, v41
    v_cvt_pk_bf16_f32 v219, v42, v43
    v_add_f32 v32, v31, v29
    v_cos_f32 v36, v31
    v_sin_f32 v37, v31
    v_add_f32 v33, v32, v29
    v_cos_f32 v38, v32
    v_sin_f32 v39, v32
    v_add_f32 v34, v33, v29
    v_cos_f32 v40, v33
    v_sin_f32 v41, v33
    v_add_f32 v31, v31, v28
    v_cos_f32 v42, v34
    v_sin_f32 v43, v34
    s_nop 0
    v_cvt_pk_bf16_f32 v220, v36, v37
    v_cvt_pk_bf16_f32 v221, v38, v39
    v_cvt_pk_bf16_f32 v222, v40, v41
    v_cvt_pk_bf16_f32 v223, v42, v43
    s_add_u32 m0, s34, 81920
    s_movk_i32 s32, 640
    buffer_load_dwordx4 v8, s[20:23], s32 offen lds
    s_add_u32 m0, s34, 82944
    s_movk_i32 s32, 640
    buffer_load_dwordx4 v9, s[20:23], s32 offen lds
    s_add_u32 m0, s33, 90112
    s_movk_i32 s32, 640
    buffer_load_dwordx4 v26, s[16:19], s32 offen lds
    s_add_u32 m0, s33, 91136
    s_movk_i32 s32, 640
    buffer_load_dwordx4 v27, s[16:19], s32 offen lds
    v_add_f32 v32, v30, v29
    v_cos_f32 v36, v30
    v_sin_f32 v37, v30
    v_add_f32 v33, v32, v29
    v_cos_f32 v38, v32
    v_sin_f32 v39, v32
    v_add_f32 v34, v33, v29
    v_cos_f32 v40, v33
    v_sin_f32 v41, v33
    v_add_f32 v30, v30, v28
    v_cos_f32 v42, v34
    v_sin_f32 v43, v34
    s_nop 0
    v_cvt_pk_bf16_f32 v224, v36, v37
    v_cvt_pk_bf16_f32 v225, v38, v39
    v_cvt_pk_bf16_f32 v226, v40, v41
    v_cvt_pk_bf16_f32 v227, v42, v43
    v_add_f32 v32, v31, v29
    v_cos_f32 v36, v31
    v_sin_f32 v37, v31
    v_add_f32 v33, v32, v29
    v_cos_f32 v38, v32
    v_sin_f32 v39, v32
    v_add_f32 v34, v33, v29
    v_cos_f32 v40, v33
    v_sin_f32 v41, v33
    v_add_f32 v31, v31, v28
    v_cos_f32 v42, v34
    v_sin_f32 v43, v34
    s_nop 0
    v_cvt_pk_bf16_f32 v228, v36, v37
    v_cvt_pk_bf16_f32 v229, v38, v39
    v_cvt_pk_bf16_f32 v230, v40, v41
    v_cvt_pk_bf16_f32 v231, v42, v43
    s_add_u32 m0, s34, 98304
    s_movk_i32 s32, 768
    buffer_load_dwordx4 v8, s[20:23], s32 offen lds
    s_add_u32 m0, s34, 99328
    s_movk_i32 s32, 768
    buffer_load_dwordx4 v9, s[20:23], s32 offen lds
    s_add_u32 m0, s33, 106496
    s_movk_i32 s32, 768
    buffer_load_dwordx4 v26, s[16:19], s32 offen lds
    s_add_u32 m0, s33, 107520
    s_movk_i32 s32, 768
    buffer_load_dwordx4 v27, s[16:19], s32 offen lds
    v_add_f32 v32, v30, v29
    v_cos_f32 v36, v30
    v_sin_f32 v37, v30
    v_add_f32 v33, v32, v29
    v_cos_f32 v38, v32
    v_sin_f32 v39, v32
    v_add_f32 v34, v33, v29
    v_cos_f32 v40, v33
    v_sin_f32 v41, v33
    v_add_f32 v30, v30, v28
    v_cos_f32 v42, v34
    v_sin_f32 v43, v34
    s_nop 0
    v_cvt_pk_bf16_f32 v232, v36, v37
    v_cvt_pk_bf16_f32 v233, v38, v39
    v_cvt_pk_bf16_f32 v234, v40, v41
    v_cvt_pk_bf16_f32 v235, v42, v43
    v_add_f32 v32, v31, v29
    v_cos_f32 v36, v31
    v_sin_f32 v37, v31
    v_add_f32 v33, v32, v29
    v_cos_f32 v38, v32
    v_sin_f32 v39, v32
    v_add_f32 v34, v33, v29
    v_cos_f32 v40, v33
    v_sin_f32 v41, v33
    v_add_f32 v31, v31, v28
    v_cos_f32 v42, v34
    v_sin_f32 v43, v34
    s_nop 0
    v_cvt_pk_bf16_f32 v236, v36, v37
    v_cvt_pk_bf16_f32 v237, v38, v39
    v_cvt_pk_bf16_f32 v238, v40, v41
    v_cvt_pk_bf16_f32 v239, v42, v43
    s_add_u32 m0, s34, 114688
    s_movk_i32 s32, 896
    buffer_load_dwordx4 v8, s[20:23], s32 offen lds
    s_add_u32 m0, s34, 115712
    s_movk_i32 s32, 896
    buffer_load_dwordx4 v9, s[20:23], s32 offen lds
    s_add_u32 m0, s33, 122880
    s_movk_i32 s32, 896
    buffer_load_dwordx4 v26, s[16:19], s32 offen lds
    s_add_u32 m0, s33, 123904
    s_movk_i32 s32, 896
    buffer_load_dwordx4 v27, s[16:19], s32 offen lds
    v_add_f32 v32, v30, v29
    v_cos_f32 v36, v30
    v_sin_f32 v37, v30
    v_add_f32 v33, v32, v29
    v_cos_f32 v38, v32
    v_sin_f32 v39, v32
    v_add_f32 v34, v33, v29
    v_cos_f32 v40, v33
    v_sin_f32 v41, v33
    v_add_f32 v30, v30, v28
    v_cos_f32 v42, v34
    v_sin_f32 v43, v34
    s_nop 0
    v_cvt_pk_bf16_f32 v240, v36, v37
    v_cvt_pk_bf16_f32 v241, v38, v39
    v_cvt_pk_bf16_f32 v242, v40, v41
    v_cvt_pk_bf16_f32 v243, v42, v43
    v_add_f32 v32, v31, v29
    v_cos_f32 v36, v31
    v_sin_f32 v37, v31
    v_add_f32 v33, v32, v29
    v_cos_f32 v38, v32
    v_sin_f32 v39, v32
    v_add_f32 v34, v33, v29
    v_cos_f32 v40, v33
    v_sin_f32 v41, v33
    v_add_f32 v31, v31, v28
    v_cos_f32 v42, v34
    v_sin_f32 v43, v34
    s_nop 0
    v_cvt_pk_bf16_f32 v244, v36, v37
    v_cvt_pk_bf16_f32 v245, v38, v39
    v_cvt_pk_bf16_f32 v246, v40, v41
    v_cvt_pk_bf16_f32 v247, v42, v43
    s_cmp_ge_u32 s2, 8
    s_cbranch_scc1 z_2
    s_cmp_lg_u32 s10, 3
    s_cbranch_scc1 z_2
    s_waitcnt vmcnt(32)
    v_mov_b32 v2, 0
    v_mov_b32 v3, 1
    s_mov_b64 exec, 1
    global_atomic_add v2, v3, s[96:97] sc1
    s_mov_b64 exec, -1
z_2:
    s_and_b32 s54, s2, 15
    s_lshr_b32 s55, s2, 4
    s_mul_i32 s56, s54, 224
    s_mul_i32 s57, s55, 32*3584
    s_add_u32 s56, s56, s57
    s_mov_b32 s24, s64
    s_mov_b32 s25, s65
    s_mov_b32 s26, 0x1c0000
    s_mov_b32 s27, 0x20000
    s_mov_b32 s28, s66
    s_mov_b32 s29, s67
    s_mov_b32 s30, 0x1c0000
    s_mov_b32 s31, 0x20000
    s_movk_i32 s58, 4682
    s_movk_i32 s59, 3584
    s_add_u32 s36, s10, 0
    s_cmp_ge_u32 s36, 7
    s_cselect_b32 s37, 7, 0
    s_sub_u32 s37, s36, s37
    s_lshl_b32 s38, s37, 6
    v_add_u32 v4, s38, v0
    v_mul_u32_u24 v5, s58, v4
    v_lshrrev_b32 v5, 16, v5
    v_mul_u32_u24 v6, 14, v5
    v_sub_u32 v6, v4, v6
    v_mul_u32_u24 v5, s59, v5
    v_lshl_add_u32 v5, v6, 4, v5
    s_lshl_b32 s38, s36, 10
    s_add_u32 m0, s38, 132096
    s_cmp_ge_u32 s36, 7
    s_cbranch_scc1 suu_4
    buffer_load_dwordx4 v5, s[24:27], s56 offen lds
    s_branch suj_5
suu_4:
    buffer_load_dwordx4 v5, s[28:31], s56 offen lds
suj_5:
    s_add_u32 s36, s10, 4
    s_cmp_ge_u32 s36, 7
    s_cselect_b32 s37, 7, 0
    s_sub_u32 s37, s36, s37
    s_lshl_b32 s38, s37, 6
    v_add_u32 v4, s38, v0
    v_mul_u32_u24 v5, s58, v4
    v_lshrrev_b32 v5, 16, v5
    v_mul_u32_u24 v6, 14, v5
    v_sub_u32 v6, v4, v6
    v_mul_u32_u24 v5, s59, v5
    v_lshl_add_u32 v5, v6, 4, v5
    s_lshl_b32 s38, s36, 10
    s_add_u32 m0, s38, 132096
    s_cmp_ge_u32 s36, 7
    s_cbranch_scc1 suu_7
    buffer_load_dwordx4 v5, s[24:27], s56 offen lds
    s_branch suj_8
suu_7:
    buffer_load_dwordx4 v5, s[28:31], s56 offen lds
suj_8:
    s_add_u32 s36, s10, 8
    s_cmp_ge_u32 s36, 7
    s_cselect_b32 s37, 7, 0
    s_sub_u32 s37, s36, s37
    s_lshl_b32 s38, s37, 6
    v_add_u32 v4, s38, v0
    v_mul_u32_u24 v5, s58, v4
    v_lshrrev_b32 v5, 16, v5
    v_mul_u32_u24 v6, 14, v5
    v_sub_u32 v6, v4, v6
    v_mul_u32_u24 v5, s59, v5
    v_lshl_add_u32 v5, v6, 4, v5
    s_lshl_b32 s38, s36, 10
    s_add_u32 m0, s38, 132096
    s_cmp_ge_u32 s36, 7
    s_cbranch_scc1 suu_10
    buffer_load_dwordx4 v5, s[24:27], s56 offen lds
    s_branch suj_11
suu_10:
    buffer_load_dwordx4 v5, s[28:31], s56 offen lds
suj_11:
    s_cmp_ge_u32 s10, 2
    s_cbranch_scc1 su_12
    s_add_u32 s36, s10, 12
    s_cmp_ge_u32 s36, 7
    s_cselect_b32 s37, 7, 0
    s_sub_u32 s37, s36, s37
    s_lshl_b32 s38, s37, 6
    v_add_u32 v4, s38, v0
    v_mul_u32_u24 v5, s58, v4
    v_lshrrev_b32 v5, 16, v5
    v_mul_u32_u24 v6, 14, v5
    v_sub_u32 v6, v4, v6
    v_mul_u32_u24 v5, s59, v5
    v_lshl_add_u32 v5, v6, 4, v5
    s_lshl_b32 s38, s36, 10
    s_add_u32 m0, s38, 132096
    s_cmp_ge_u32 s36, 7
    s_cbranch_scc1 suu_13
    buffer_load_dwordx4 v5, s[24:27], s56 offen lds
    s_branch suj_14
suu_13:
    buffer_load_dwordx4 v5, s[28:31], s56 offen lds
suj_14:
su_12:
    s_cmp_ge_u32 s2, 224
    s_cbranch_scc1 su_15
    s_mov_b32 s24, s68
    s_mov_b32 s25, s69
    s_mov_b32 s26, 0x1c0000
    s_mov_b32 s27, 0x20000
    s_lshr_b32 s54, s2, 1
    s_lshl_b32 s54, s54, 14
    s_and_b32 s55, s2, 1
    s_lshl_b32 s55, s55, 9
    s_add_u32 s54, s54, s55
    s_lshl_b32 s55, s10, 12
    s_add_u32 s54, s54, s55
    v_lshrrev_b32 v4, 5, v0
    v_and_b32 v5, 31, v0
    v_lshlrev_b32 v5, 4, v5
    v_lshl_add_u32 v5, v4, 10, v5
    s_lshl_b32 s55, s10, 11
    s_add_u32 m0, s55, 146432
    s_add_u32 s36, s54, 0
    buffer_load_dwordx4 v5, s[24:27], s36 offen lds
    s_add_u32 m0, s55, 147456
    s_add_u32 s36, s54, 2048
    buffer_load_dwordx4 v5, s[24:27], s36 offen lds
su_15:
    s_and_b32 s13, s11, 3
    s_lshl_b32 s13, s13, 2
    s_and_b32 s14, s12, 3
    s_add_u32 s13, s13, s14
    s_lshr_b32 s14, s11, 2
    s_lshl_b32 s14, s14, 3
    s_lshr_b32 s15, s12, 2
    s_add_u32 s89, s14, s15
    s_mul_i32 s88, s13, 7
    s_lshl_b32 s41, s88, 15
    s_add_u32 s41, s41, 0x1000000
    s_add_u32 s84, s4, s41
    s_addc_u32 s85, s5, 0
    s_mov_b32 s86, 0x38000
    s_mov_b32 s87, 0x20000
    s_lshl_b32 s83, s10, 13
    s_and_b32 s13, s12, 7
    s_mul_i32 s14, s13, 229376
    s_add_u32 s14, s14, 0x1400000
    s_add_u32 s92, s4, s14
    s_addc_u32 s93, s5, 0
    s_mov_b32 s94, 0x38000
    s_mov_b32 s95, 0x20000
    s_mul_i32 s90, s10, 28672
    s_mov_b32 s13, 0
    s_cmp_eq_u32 s13, 3
    s_cselect_b32 s14, 0, s13
    s_add_u32 s15, s14, 0
    s_cmp_ge_u32 s15, 3
    s_cselect_b32 s41, 3, 0
    s_sub_u32 s15, s15, s41
    s_lshl_b32 s15, s15, 10
    s_add_u32 s0, s15, s90
    s_add_u32 s15, s14, 1
    s_cmp_ge_u32 s15, 3
    s_cselect_b32 s41, 3, 0
    s_sub_u32 s15, s15, s41
    s_lshl_b32 s15, s15, 10
    s_add_u32 s1, s15, s90
    s_add_u32 s15, s14, 2
    s_cmp_ge_u32 s15, 3
    s_cselect_b32 s41, 3, 0
    s_sub_u32 s15, s15, s41
    s_lshl_b32 s15, s15, 10
    s_add_u32 s3, s15, s90
    s_add_u32 s15, s13, 0
    s_and_b32 s15, s15, 3
    s_add_u32 s15, s15, 3
    s_lshl_b32 s15, s15, 10
    s_add_u32 s77, s15, s90
    s_add_u32 s15, s13, 1
    s_and_b32 s15, s15, 3
    s_add_u32 s15, s15, 3
    s_lshl_b32 s15, s15, 10
    s_add_u32 s81, s15, s90
    s_add_u32 s15, s13, 2
    s_and_b32 s15, s15, 3
    s_add_u32 s15, s15, 3
    s_lshl_b32 s15, s15, 10
    s_add_u32 s98, s15, s90
    s_add_u32 s15, s13, 3
    s_and_b32 s15, s15, 3
    s_add_u32 s15, s15, 3
    s_lshl_b32 s15, s15, 10
    s_add_u32 s99, s15, s90
    s_and_b32 s13, s12, 7
    s_lshr_b32 s14, s12, 3
    s_and_b32 s50, s10, 1
    s_lshr_b32 s51, s10, 1
    v_and_b32 v2, 15, v0
    v_lshrrev_b32 v3, 4, v0
    v_lshrrev_b32 v4, 1, v2
    s_lshl_b32 s52, s51, 2
    v_add_u32 v5, s52, v3
    v_xor_b32 v6, v5, v4
    v_lshlrev_b32 v6, 4, v6
    v_lshl_add_u32 v6, v2, 7, v6
    v_xor_b32 v7, 64, v6
    s_lshl_b32 s53, s51, 12
    s_add_u32 s53, s53, 8192
    v_add_u32 v18, s53, v6
    v_add_u32 v19, s53, v7
    s_lshl_b32 s53, s50, 12
    s_add_u32 s54, s53, 0
    v_add_u32 v10, s54, v6
    v_add_u32 v11, s54, v7
    s_add_u32 s54, s53, 2048
    v_add_u32 v12, s54, v6
    v_add_u32 v13, s54, v7
    v_add_u32 v14, 0x10000, v10
    v_add_u32 v15, 0x10000, v11
    v_add_u32 v16, 0x10000, v12
    v_add_u32 v17, 0x10000, v13
    v_add_u32 v20, 0x10000, v18
    v_add_u32 v21, 0x10000, v19
    s_lshl_b32 s54, s11, 2
    s_add_u32 s54, s54, s14
    s_lshl_b32 s54, s54, 10
    s_lshl_b32 s55, s50, 9
    s_add_u32 s54, s54, s55
    s_lshl_b32 s55, s13, 15
    s_lshl_b32 s56, s51, 8
    s_add_u32 s55, s55, s56
    s_add_u32 s55, s55, s54
    v_lshlrev_b32 v4, 4, v2
    v_lshlrev_b32 v6, 19, v3
    v_add_u32 v22, s55, v4
    v_add_u32 v22, v22, v6
    s_sub_u32 s55, 15, s13
    s_lshl_b32 s55, s55, 15
    s_add_u32 s55, s55, s54
    s_add_u32 s55, s55, 496
    s_sub_u32 s55, s55, s56
    v_sub_u32 v5, s55, v4
    v_sub_u32 v4, 8, v3
    v_and_b32 v4, 7, v4
    v_lshlrev_b32 v4, 19, v4
    v_add_u32 v23, v5, v4
    v_sub_u32 v4, 4, v3
    v_lshlrev_b32 v4, 19, v4
    v_add_u32 v27, v5, v4
    v_mov_b32 v92, 0
    v_mov_b32 v93, 0
    v_mov_b32 v94, 0
    v_mov_b32 v95, 0
    v_mov_b32 v96, 0
    v_mov_b32 v97, 0
    v_mov_b32 v98, 0
    v_mov_b32 v99, 0
    v_mov_b32 v100, 0
    v_mov_b32 v101, 0
    v_mov_b32 v102, 0
    v_mov_b32 v103, 0
    v_mov_b32 v104, 0
    v_mov_b32 v105, 0
    v_mov_b32 v106, 0
    v_mov_b32 v107, 0
    v_mov_b32 v108, 0
    v_mov_b32 v109, 0
    v_mov_b32 v110, 0
    v_mov_b32 v111, 0
    s_mov_b32 s75, 0x3f803f80
    s_lshl_b32 s54, s50, 9
    s_add_u32 s54, s54, 131072
    v_and_b32 v4, 31, v0
    s_lshl_b32 s55, s51, 3
    s_add_u32 s55, s55, s54
    v_lshlrev_b32 v24, 4, v4
    v_add_u32 v24, s55, v24
    v_lshlrev_b32 v25, 6, v3
    v_add_u32 v25, s54, v25
    s_add_u32 s28, s4, 0x600000
    s_addc_u32 s29, s5, 0
    s_mov_b32 s30, 0x400000
    s_mov_b32 s31, 0x20000
    s_waitcnt vmcnt(31)
    s_barrier
    ds_read_b128 v[28:31], v10 offset:0
    ds_read_b128 v[32:35], v12 offset:0
    ds_read_b128 v[44:47], v18 offset:0
    ds_read_b128 v[48:51], v18 offset:2048
    ds_read_b128 v[36:39], v11 offset:0
    ds_read_b128 v[40:43], v13 offset:0
    ds_read_b128 v[52:55], v19 offset:0
    ds_read_b128 v[56:59], v19 offset:2048
    s_waitcnt vmcnt(27)
    s_barrier
    s_waitcnt lgkmcnt(0)
    ds_read_b128 v[60:63], v10 offset:16384
    v_mfma_f32_16x16x32_bf16 v[92:95], v[28:31], v[44:47], v[92:95]
    v_dot2_f32_bf16 v108, v28, s75, v108
    v_dot2_f32_bf16 v109, v28, v28, v109
    ds_read_b128 v[64:67], v12 offset:16384
    v_mfma_f32_16x16x32_bf16 v[96:99], v[32:35], v[44:47], v[96:99]
    v_dot2_f32_bf16 v108, v29, s75, v108
    v_dot2_f32_bf16 v109, v29, v29, v109
    ds_read_b128 v[76:79], v18 offset:16384
    v_mfma_f32_16x16x32_bf16 v[100:103], v[28:31], v[48:51], v[100:103]
    v_dot2_f32_bf16 v108, v30, s75, v108
    v_dot2_f32_bf16 v109, v30, v30, v109
    ds_read_b128 v[80:83], v18 offset:18432
    v_mfma_f32_16x16x32_bf16 v[104:107], v[32:35], v[48:51], v[104:107]
    v_dot2_f32_bf16 v108, v31, s75, v108
    v_dot2_f32_bf16 v109, v31, v31, v109
    ds_read_b128 v[68:71], v11 offset:16384
    v_mfma_f32_16x16x32_bf16 v[92:95], v[36:39], v[52:55], v[92:95]
    v_dot2_f32_bf16 v110, v32, s75, v110
    v_dot2_f32_bf16 v111, v32, v32, v111
    ds_read_b128 v[72:75], v13 offset:16384
    v_mfma_f32_16x16x32_bf16 v[96:99], v[40:43], v[52:55], v[96:99]
    v_dot2_f32_bf16 v110, v33, s75, v110
    v_dot2_f32_bf16 v111, v33, v33, v111
    ds_read_b128 v[84:87], v19 offset:16384
    v_mfma_f32_16x16x32_bf16 v[100:103], v[36:39], v[56:59], v[100:103]
    v_dot2_f32_bf16 v110, v34, s75, v110
    v_dot2_f32_bf16 v111, v34, v34, v111
    ds_read_b128 v[88:91], v19 offset:18432
    v_mfma_f32_16x16x32_bf16 v[104:107], v[40:43], v[56:59], v[104:107]
    v_dot2_f32_bf16 v110, v35, s75, v110
    v_dot2_f32_bf16 v111, v35, v35, v111
    s_waitcnt vmcnt(23)
    s_barrier
    s_waitcnt lgkmcnt(0)
    ds_read_b128 v[28:31], v10 offset:32768
    v_mfma_f32_16x16x32_bf16 v[92:95], v[60:63], v[76:79], v[92:95]
    v_dot2_f32_bf16 v108, v60, s75, v108
    v_dot2_f32_bf16 v109, v60, v60, v109
    ds_read_b128 v[32:35], v12 offset:32768
    v_mfma_f32_16x16x32_bf16 v[96:99], v[64:67], v[76:79], v[96:99]
    v_dot2_f32_bf16 v108, v61, s75, v108
    v_dot2_f32_bf16 v109, v61, v61, v109
    ds_read_b128 v[44:47], v18 offset:32768
    v_mfma_f32_16x16x32_bf16 v[100:103], v[60:63], v[80:83], v[100:103]
    v_dot2_f32_bf16 v108, v62, s75, v108
    v_dot2_f32_bf16 v109, v62, v62, v109
    ds_read_b128 v[48:51], v18 offset:34816
    v_mfma_f32_16x16x32_bf16 v[104:107], v[64:67], v[80:83], v[104:107]
    v_dot2_f32_bf16 v108, v63, s75, v108
    v_dot2_f32_bf16 v109, v63, v63, v109
    ds_read_b128 v[36:39], v11 offset:32768
    v_mfma_f32_16x16x32_bf16 v[92:95], v[68:71], v[84:87], v[92:95]
    v_dot2_f32_bf16 v110, v64, s75, v110
    v_dot2_f32_bf16 v111, v64, v64, v111
    ds_read_b128 v[40:43], v13 offset:32768
    v_mfma_f32_16x16x32_bf16 v[96:99], v[72:75], v[84:87], v[96:99]
    v_dot2_f32_bf16 v110, v65, s75, v110
    v_dot2_f32_bf16 v111, v65, v65, v111
    ds_read_b128 v[52:55], v19 offset:32768
    v_mfma_f32_16x16x32_bf16 v[100:103], v[68:71], v[88:91], v[100:103]
    v_dot2_f32_bf16 v110, v66, s75, v110
    v_dot2_f32_bf16 v111, v66, v66, v111
    ds_read_b128 v[56:59], v19 offset:34816
    v_mfma_f32_16x16x32_bf16 v[104:107], v[72:75], v[88:91], v[104:107]
    v_dot2_f32_bf16 v110, v67, s75, v110
    v_dot2_f32_bf16 v111, v67, v67, v111
    s_waitcnt vmcnt(19)
    s_barrier
    s_waitcnt lgkmcnt(0)
    ds_read_b128 v[60:63], v10 offset:49152
    v_mfma_f32_16x16x32_bf16 v[92:95], v[28:31], v[44:47], v[92:95]
    v_dot2_f32_bf16 v108, v28, s75, v108
    v_dot2_f32_bf16 v109, v28, v28, v109
    ds_read_b128 v[64:67], v12 offset:49152
    v_mfma_f32_16x16x32_bf16 v[96:99], v[32:35], v[44:47], v[96:99]
    v_dot2_f32_bf16 v108, v29, s75, v108
    v_dot2_f32_bf16 v109, v29, v29, v109
    ds_read_b128 v[76:79], v18 offset:49152
    v_mfma_f32_16x16x32_bf16 v[100:103], v[28:31], v[48:51], v[100:103]
    v_dot2_f32_bf16 v108, v30, s75, v108
    v_dot2_f32_bf16 v109, v30, v30, v109
    ds_read_b128 v[80:83], v18 offset:51200
    v_mfma_f32_16x16x32_bf16 v[104:107], v[32:35], v[48:51], v[104:107]
    v_dot2_f32_bf16 v108, v31, s75, v108
    v_dot2_f32_bf16 v109, v31, v31, v109
    ds_read_b128 v[68:71], v11 offset:49152
    v_mfma_f32_16x16x32_bf16 v[92:95], v[36:39], v[52:55], v[92:95]
    v_dot2_f32_bf16 v110, v32, s75, v110
    v_dot2_f32_bf16 v111, v32, v32, v111
    ds_read_b128 v[72:75], v13 offset:49152
    v_mfma_f32_16x16x32_bf16 v[96:99], v[40:43], v[52:55], v[96:99]
    v_dot2_f32_bf16 v110, v33, s75, v110
    v_dot2_f32_bf16 v111, v33, v33, v111
    ds_read_b128 v[84:87], v19 offset:49152
    v_mfma_f32_16x16x32_bf16 v[100:103], v[36:39], v[56:59], v[100:103]
    v_dot2_f32_bf16 v110, v34, s75, v110
    v_dot2_f32_bf16 v111, v34, v34, v111
    ds_read_b128 v[88:91], v19 offset:51200
    v_mfma_f32_16x16x32_bf16 v[104:107], v[40:43], v[56:59], v[104:107]
    v_dot2_f32_bf16 v110, v35, s75, v110
    v_dot2_f32_bf16 v111, v35, v35, v111
    s_waitcnt vmcnt(15)
    s_barrier
    s_waitcnt lgkmcnt(0)
    ds_read_b128 v[28:31], v14 offset:0
    v_mfma_f32_16x16x32_bf16 v[92:95], v[60:63], v[76:79], v[92:95]
    v_dot2_f32_bf16 v108, v60, s75, v108
    v_dot2_f32_bf16 v109, v60, v60, v109
    ds_read_b128 v[32:35], v16 offset:0
    v_mfma_f32_16x16x32_bf16 v[96:99], v[64:67], v[76:79], v[96:99]
    v_dot2_f32_bf16 v108, v61, s75, v108
    v_dot2_f32_bf16 v109, v61, v61, v109
    ds_read_b128 v[44:47], v20 offset:0
    v_mfma_f32_16x16x32_bf16 v[100:103], v[60:63], v[80:83], v[100:103]
    v_dot2_f32_bf16 v108, v62, s75, v108
    v_dot2_f32_bf16 v109, v62, v62, v109
    ds_read_b128 v[48:51], v20 offset:2048
    v_mfma_f32_16x16x32_bf16 v[104:107], v[64:67], v[80:83], v[104:107]
    v_dot2_f32_bf16 v108, v63, s75, v108
    v_dot2_f32_bf16 v109, v63, v63, v109
    ds_read_b128 v[36:39], v15 offset:0
    v_mfma_f32_16x16x32_bf16 v[92:95], v[68:71], v[84:87], v[92:95]
    v_dot2_f32_bf16 v110, v64, s75, v110
    v_dot2_f32_bf16 v111, v64, v64, v111
    ds_read_b128 v[40:43], v17 offset:0
    v_mfma_f32_16x16x32_bf16 v[96:99], v[72:75], v[84:87], v[96:99]
    v_dot2_f32_bf16 v110, v65, s75, v110
    v_dot2_f32_bf16 v111, v65, v65, v111
    ds_read_b128 v[52:55], v21 offset:0
    v_mfma_f32_16x16x32_bf16 v[100:103], v[68:71], v[88:91], v[100:103]
    v_dot2_f32_bf16 v110, v66, s75, v110
    v_dot2_f32_bf16 v111, v66, v66, v111
    ds_read_b128 v[56:59], v21 offset:2048
    v_mfma_f32_16x16x32_bf16 v[104:107], v[72:75], v[88:91], v[104:107]
    v_dot2_f32_bf16 v110, v67, s75, v110
    v_dot2_f32_bf16 v111, v67, v67, v111
    s_waitcnt vmcnt(11)
    s_barrier
    s_waitcnt lgkmcnt(0)
    ds_read_b128 v[60:63], v14 offset:16384
    v_mfma_f32_16x16x32_bf16 v[92:95], v[28:31], v[44:47], v[92:95]
    v_dot2_f32_bf16 v108, v28, s75, v108
    v_dot2_f32_bf16 v109, v28, v28, v109
    ds_read_b128 v[64:67], v16 offset:16384
    v_mfma_f32_16x16x32_bf16 v[96:99], v[32:35], v[44:47], v[96:99]
    v_dot2_f32_bf16 v108, v29, s75, v108
    v_dot2_f32_bf16 v109, v29, v29, v109
    ds_read_b128 v[76:79], v20 offset:16384
    v_mfma_f32_16x16x32_bf16 v[100:103], v[28:31], v[48:51], v[100:103]
    v_dot2_f32_bf16 v108, v30, s75, v108
    v_dot2_f32_bf16 v109, v30, v30, v109
    ds_read_b128 v[80:83], v20 offset:18432
    v_mfma_f32_16x16x32_bf16 v[104:107], v[32:35], v[48:51], v[104:107]
    v_dot2_f32_bf16 v108, v31, s75, v108
    v_dot2_f32_bf16 v109, v31, v31, v109
    ds_read_b128 v[68:71], v15 offset:16384
    v_mfma_f32_16x16x32_bf16 v[92:95], v[36:39], v[52:55], v[92:95]
    v_dot2_f32_bf16 v110, v32, s75, v110
    v_dot2_f32_bf16 v111, v32, v32, v111
    ds_read_b128 v[72:75], v17 offset:16384
    v_mfma_f32_16x16x32_bf16 v[96:99], v[40:43], v[52:55], v[96:99]
    v_dot2_f32_bf16 v110, v33, s75, v110
    v_dot2_f32_bf16 v111, v33, v33, v111
    ds_read_b128 v[84:87], v21 offset:16384
    v_mfma_f32_16x16x32_bf16 v[100:103], v[36:39], v[56:59], v[100:103]
    v_dot2_f32_bf16 v110, v34, s75, v110
    v_dot2_f32_bf16 v111, v34, v34, v111
    ds_read_b128 v[88:91], v21 offset:18432
    v_mfma_f32_16x16x32_bf16 v[104:107], v[40:43], v[56:59], v[104:107]
    v_dot2_f32_bf16 v110, v35, s75, v110
    v_dot2_f32_bf16 v111, v35, v35, v111
    s_waitcnt vmcnt(7)
    s_barrier
    s_waitcnt lgkmcnt(0)
    ds_read_b128 v[28:31], v14 offset:32768
    v_mfma_f32_16x16x32_bf16 v[92:95], v[60:63], v[76:79], v[92:95]
    v_dot2_f32_bf16 v108, v60, s75, v108
    v_dot2_f32_bf16 v109, v60, v60, v109
    ds_read_b128 v[32:35], v16 offset:32768
    v_mfma_f32_16x16x32_bf16 v[96:99], v[64:67], v[76:79], v[96:99]
    v_dot2_f32_bf16 v108, v61, s75, v108
    v_dot2_f32_bf16 v109, v61, v61, v109
    ds_read_b128 v[44:47], v20 offset:32768
    v_mfma_f32_16x16x32_bf16 v[100:103], v[60:63], v[80:83], v[100:103]
    v_dot2_f32_bf16 v108, v62, s75, v108
    v_dot2_f32_bf16 v109, v62, v62, v109
    ds_read_b128 v[48:51], v20 offset:34816
    v_mfma_f32_16x16x32_bf16 v[104:107], v[64:67], v[80:83], v[104:107]
    v_dot2_f32_bf16 v108, v63, s75, v108
    v_dot2_f32_bf16 v109, v63, v63, v109
    ds_read_b128 v[36:39], v15 offset:32768
    v_mfma_f32_16x16x32_bf16 v[92:95], v[68:71], v[84:87], v[92:95]
    v_dot2_f32_bf16 v110, v64, s75, v110
    v_dot2_f32_bf16 v111, v64, v64, v111
    ds_read_b128 v[40:43], v17 offset:32768
    v_mfma_f32_16x16x32_bf16 v[96:99], v[72:75], v[84:87], v[96:99]
    v_dot2_f32_bf16 v110, v65, s75, v110
    v_dot2_f32_bf16 v111, v65, v65, v111
    ds_read_b128 v[52:55], v21 offset:32768
    v_mfma_f32_16x16x32_bf16 v[100:103], v[68:71], v[88:91], v[100:103]
    v_dot2_f32_bf16 v110, v66, s75, v110
    v_dot2_f32_bf16 v111, v66, v66, v111
    ds_read_b128 v[56:59], v21 offset:34816
    v_mfma_f32_16x16x32_bf16 v[104:107], v[72:75], v[88:91], v[104:107]
    v_dot2_f32_bf16 v110, v67, s75, v110
    v_dot2_f32_bf16 v111, v67, v67, v111
    s_waitcnt vmcnt(3)
    s_barrier
    s_waitcnt lgkmcnt(0)
    ds_read_b128 v[60:63], v14 offset:49152
    v_mfma_f32_16x16x32_bf16 v[92:95], v[28:31], v[44:47], v[92:95]
    v_dot2_f32_bf16 v108, v28, s75, v108
    v_dot2_f32_bf16 v109, v28, v28, v109
    ds_read_b128 v[64:67], v16 offset:49152
    v_mfma_f32_16x16x32_bf16 v[96:99], v[32:35], v[44:47], v[96:99]
    v_dot2_f32_bf16 v108, v29, s75, v108
    v_dot2_f32_bf16 v109, v29, v29, v109
    ds_read_b128 v[76:79], v20 offset:49152
    v_mfma_f32_16x16x32_bf16 v[100:103], v[28:31], v[48:51], v[100:103]
    v_dot2_f32_bf16 v108, v30, s75, v108
    v_dot2_f32_bf16 v109, v30, v30, v109
    ds_read_b128 v[80:83], v20 offset:51200
    v_mfma_f32_16x16x32_bf16 v[104:107], v[32:35], v[48:51], v[104:107]
    v_dot2_f32_bf16 v108, v31, s75, v108
    v_dot2_f32_bf16 v109, v31, v31, v109
    ds_read_b128 v[68:71], v15 offset:49152
    v_mfma_f32_16x16x32_bf16 v[92:95], v[36:39], v[52:55], v[92:95]
    v_dot2_f32_bf16 v110, v32, s75, v110
    v_dot2_f32_bf16 v111, v32, v32, v111
    ds_read_b128 v[72:75], v17 offset:49152
    v_mfma_f32_16x16x32_bf16 v[96:99], v[40:43], v[52:55], v[96:99]
    v_dot2_f32_bf16 v110, v33, s75, v110
    v_dot2_f32_bf16 v111, v33, v33, v111
    ds_read_b128 v[84:87], v21 offset:49152
    v_mfma_f32_16x16x32_bf16 v[100:103], v[36:39], v[56:59], v[100:103]
    v_dot2_f32_bf16 v110, v34, s75, v110
    v_dot2_f32_bf16 v111, v34, v34, v111
    ds_read_b128 v[88:91], v21 offset:51200
    v_mfma_f32_16x16x32_bf16 v[104:107], v[40:43], v[56:59], v[104:107]
    v_dot2_f32_bf16 v110, v35, s75, v110
    v_dot2_f32_bf16 v111, v35, v35, v111
    s_waitcnt lgkmcnt(0)
    v_mfma_f32_16x16x32_bf16 v[92:95], v[60:63], v[76:79], v[92:95]
    v_mfma_f32_16x16x32_bf16 v[96:99], v[64:67], v[76:79], v[96:99]
    v_mfma_f32_16x16x32_bf16 v[100:103], v[60:63], v[80:83], v[100:103]
    v_mfma_f32_16x16x32_bf16 v[104:107], v[64:67], v[80:83], v[104:107]
    v_mfma_f32_16x16x32_bf16 v[92:95], v[68:71], v[84:87], v[92:95]
    v_mfma_f32_16x16x32_bf16 v[96:99], v[72:75], v[84:87], v[96:99]
    v_mfma_f32_16x16x32_bf16 v[100:103], v[68:71], v[88:91], v[100:103]
    v_mfma_f32_16x16x32_bf16 v[104:107], v[72:75], v[88:91], v[104:107]
    v_dot2_f32_bf16 v108, v60, s75, v108
    v_dot2_f32_bf16 v109, v60, v60, v109
    v_dot2_f32_bf16 v108, v61, s75, v108
    v_dot2_f32_bf16 v109, v61, v61, v109
    v_dot2_f32_bf16 v108, v62, s75, v108
    v_dot2_f32_bf16 v109, v62, v62, v109
    v_dot2_f32_bf16 v108, v63, s75, v108
    v_dot2_f32_bf16 v109, v63, v63, v109
    v_dot2_f32_bf16 v110, v64, s75, v110
    v_dot2_f32_bf16 v111, v64, v64, v111
    v_dot2_f32_bf16 v110, v65, s75, v110
    v_dot2_f32_bf16 v111, v65, v65, v111
    v_dot2_f32_bf16 v110, v66, s75, v110
    v_dot2_f32_bf16 v111, v66, v66, v111
    v_dot2_f32_bf16 v110, v67, s75, v110
    v_dot2_f32_bf16 v111, v67, v67, v111
    s_waitcnt vmcnt(0)
    s_barrier
    v_lshrrev_b32 v4, 4, v0
    v_lshrrev_b32 v5, 1, v4
    v_lshlrev_b32 v5, 3, v5
    v_bfe_u32 v6, v0, 2, 2
    v_add_u32 v5, v5, v6
    v_and_b32 v4, 1, v4
    v_and_b32 v6, 3, v0
    v_mul_u32_u24 v7, 224, v5
    s_movk_i32 s54, 7168
    v_mad_u32_u24 v7, v4, s54, v7
    v_lshl_add_u32 v7, v6, 3, v7
    s_lshl_b32 s55, s10, 5
    s_add_u32 s55, s55, 132096
    v_add_u32 v7, s55, v7
    v_mov_b32 v8, 0x3f803f80
    v_mov_b32 v9, 0x3f803f80
    v_mov_b32 v10, 0x3f803f80
    v_mov_b32 v11, 0x3f803f80
    s_add_u32 s24, s4, 0x1000000
    s_addc_u32 s25, s5, 0
    s_mov_b32 s26, 0x380000
    s_mov_b32 s27, 0x20000
    s_add_u32 s28, s4, 0x2400000
    s_addc_u32 s29, s5, 0
    s_mov_b32 s30, 0x38000
    s_mov_b32 s31, 0x20000
    s_and_b32 s54, s2, 15
    s_mul_i32 s54, s54, 7
    s_lshr_b32 s56, s2, 4
    v_and_b32 v12, 31, v0
    v_lshlrev_b32 v12, 2, v12
    ds_read_b64_tr_b16 v[28:29], v7 offset:0
    ds_read_b64_tr_b16 v[30:31], v7 offset:896
    ds_read_b64_tr_b16 v[32:33], v7 offset:3584
    ds_read_b64_tr_b16 v[34:35], v7 offset:4480
    s_add_u32 s57, s54, s10
    s_lshl_b32 s58, s57, 15
    s_lshl_b32 s59, s56, 11
    s_add_u32 s58, s58, s59
    s_waitcnt lgkmcnt(0)
    buffer_store_dwordx4 v[28:31], v1, s[24:27], s58 offen offset:0 sc1
    v_mfma_f32_32x32x16_bf16 v[48:63], v[8:11], v[28:31], 0
    buffer_store_dwordx4 v[32:35], v1, s[24:27], s58 offen offset:1024 sc1
    v_mfma_f32_32x32x16_bf16 v[48:63], v[8:11], v[32:35], v[48:63]
    s_lshl_b32 s57, s57, 11
    s_lshl_b32 s59, s56, 7
    s_add_u32 s57, s57, s59
    s_nop 11
    s_mov_b64 exec, 0xffffffff
    buffer_store_dword v48, v12, s[28:31], s57 offen sc1
    s_mov_b64 exec, -1
    s_cmp_eq_u32 s10, 3
    s_cbranch_scc1 sp_17
    ds_read_b64_tr_b16 v[28:29], v7 offset:128
    ds_read_b64_tr_b16 v[30:31], v7 offset:1024
    ds_read_b64_tr_b16 v[32:33], v7 offset:3712
    ds_read_b64_tr_b16 v[34:35], v7 offset:4608
    s_add_u32 s57, s54, s10
    s_add_u32 s57, s57, 4
    s_lshl_b32 s58, s57, 15
    s_lshl_b32 s59, s56, 11
    s_add_u32 s58, s58, s59
    s_waitcnt lgkmcnt(0)
    buffer_store_dwordx4 v[28:31], v1, s[24:27], s58 offen offset:0 sc1
    v_mfma_f32_32x32x16_bf16 v[48:63], v[8:11], v[28:31], 0
    buffer_store_dwordx4 v[32:35], v1, s[24:27], s58 offen offset:1024 sc1
    v_mfma_f32_32x32x16_bf16 v[48:63], v[8:11], v[32:35], v[48:63]
    s_lshl_b32 s57, s57, 11
    s_lshl_b32 s59, s56, 7
    s_add_u32 s57, s57, s59
    s_nop 11
    s_mov_b64 exec, 0xffffffff
    buffer_store_dword v48, v12, s[28:31], s57 offen sc1
    s_mov_b64 exec, -1
sp_17:
    s_cmp_ge_u32 s2, 224
    s_cbranch_scc1 sp_18
    v_lshlrev_b32 v7, 9, v5
    v_lshl_add_u32 v7, v4, 5, v7
    v_lshl_add_u32 v7, v6, 3, v7
    s_lshl_b32 s55, s10, 7
    s_add_u32 s55, s55, 146432
    v_add_u32 v7, s55, v7
    s_add_u32 s24, s4, 0x1400000
    s_addc_u32 s25, s5, 0
    s_mov_b32 s26, 0x1c0000
    s_mov_b32 s27, 0x20000
    ds_read_b64_tr_b16 v[28:29], v7 offset:0
    ds_read_b64_tr_b16 v[30:31], v7 offset:2048
    ds_read_b64_tr_b16 v[32:33], v7 offset:64
    ds_read_b64_tr_b16 v[34:35], v7 offset:2112
    s_and_b32 s54, s2, 1
    s_lshl_b32 s54, s54, 3
    s_lshl_b32 s55, s10, 1
    s_add_u32 s54, s54, s55
    s_mul_i32 s54, s54, 112
    s_lshr_b32 s55, s2, 1
    s_add_u32 s54, s54, s55
    s_lshl_b32 s54, s54, 10
    s_add_u32 s55, s54, 114688
    s_waitcnt lgkmcnt(0)
    buffer_store_dwordx4 v[28:31], v1, s[24:27], s54 offen sc1
    buffer_store_dwordx4 v[32:35], v1, s[24:27], s55 offen sc1
sp_18:
    s_add_u32 s28, s4, 0x600000
    s_addc_u32 s29, s5, 0
    s_mov_b32 s30, 0x400000
    s_mov_b32 s31, 0x20000
    s_and_b32 s13, s12, 7
    s_lshr_b32 s14, s12, 3
    s_and_b32 s50, s10, 1
    s_lshr_b32 s51, s10, 1
    s_nop 2
    v_mov_b32 v120, v108
    v_mov_b32 v121, v109
    v_mov_b32 v122, v110
    v_mov_b32 v123, v111
    s_nop 1
    v_permlane16_swap_b32 v108, v120
    v_permlane16_swap_b32 v109, v121
    v_permlane16_swap_b32 v110, v122
    v_permlane16_swap_b32 v111, v123
    s_nop 0
    v_add_f32 v108, v108, v120
    v_add_f32 v109, v109, v121
    v_add_f32 v110, v110, v122
    v_add_f32 v111, v111, v123
    v_mov_b32 v120, v108
    v_mov_b32 v121, v109
    v_mov_b32 v122, v110
    v_mov_b32 v123, v111
    s_nop 1
    v_permlane32_swap_b32 v108, v120
    v_permlane32_swap_b32 v109, v121
    v_permlane32_swap_b32 v110, v122
    v_permlane32_swap_b32 v111, v123
    s_nop 0
    v_add_f32 v108, v108, v120
    v_add_f32 v109, v109, v121
    v_add_f32 v110, v110, v122
    v_add_f32 v111, v111, v123
    v_cmp_gt_u32 vcc, 16, v0
    s_nop 1
    v_cndmask_b32 v120, v110, v108, vcc
    v_cndmask_b32 v121, v111, v109, vcc
    s_mov_b64 exec, 0xffffffff
    ds_write_b64 v24, v[120:121]
    s_mov_b64 exec, -1
    s_waitcnt lgkmcnt(0)
    s_barrier
    ds_read_b128 v[152:155], v25 offset:0
    ds_read_b128 v[156:159], v25 offset:16
    ds_read_b128 v[160:163], v25 offset:32
    ds_read_b128 v[164:167], v25 offset:48
    ds_read_b128 v[168:171], v25 offset:256
    ds_read_b128 v[172:175], v25 offset:272
    ds_read_b128 v[176:179], v25 offset:288
    ds_read_b128 v[180:183], v25 offset:304
    s_waitcnt lgkmcnt(0)
    s_mov_b32 s78, 0x3b000000
    s_mov_b32 s79, 0x3b000000
    v_pk_add_f32 v[152:153], v[152:153], v[154:155]
    v_pk_add_f32 v[156:157], v[156:157], v[158:159]
    v_pk_add_f32 v[160:161], v[160:161], v[162:163]
    v_pk_add_f32 v[164:165], v[164:165], v[166:167]
    v_pk_add_f32 v[168:169], v[168:169], v[170:171]
    v_pk_add_f32 v[172:173], v[172:173], v[174:175]
    v_pk_add_f32 v[176:177], v[176:177], v[178:179]
    v_pk_add_f32 v[180:181], v[180:181], v[182:183]
    v_pk_mul_f32 v[152:153], v[152:153], s[78:79]
    v_pk_mul_f32 v[156:157], v[156:157], s[78:79]
    v_pk_mul_f32 v[160:161], v[160:161], s[78:79]
    v_pk_mul_f32 v[164:165], v[164:165], s[78:79]
    v_pk_mul_f32 v[168:169], v[168:169], s[78:79]
    v_pk_mul_f32 v[172:173], v[172:173], s[78:79]
    v_pk_mul_f32 v[176:177], v[176:177], s[78:79]
    v_pk_mul_f32 v[180:181], v[180:181], s[78:79]
    v_fma_f32 v153, -v152, v152, v153
    v_fma_f32 v157, -v156, v156, v157
    v_fma_f32 v161, -v160, v160, v161
    v_fma_f32 v165, -v164, v164, v165
    v_fma_f32 v169, -v168, v168, v169
    v_fma_f32 v173, -v172, v172, v173
    v_fma_f32 v177, -v176, v176, v177
    v_fma_f32 v181, -v180, v180, v181
    v_add_f32 v153, 0x3727c5ac, v153
    v_add_f32 v157, 0x3727c5ac, v157
    v_add_f32 v161, 0x3727c5ac, v161
    v_add_f32 v165, 0x3727c5ac, v165
    v_add_f32 v169, 0x3727c5ac, v169
    v_add_f32 v173, 0x3727c5ac, v173
    v_add_f32 v177, 0x3727c5ac, v177
    v_add_f32 v181, 0x3727c5ac, v181
    v_rsq_f32 v112, v153
    v_rsq_f32 v113, v157
    v_rsq_f32 v114, v161
    v_rsq_f32 v115, v165
    v_rsq_f32 v116, v169
    v_rsq_f32 v117, v173
    v_rsq_f32 v118, v177
    v_rsq_f32 v119, v181
    s_nop 0
    v_pk_mul_f32 v[92:93], v[92:93], v[112:113]
    v_pk_mul_f32 v[94:95], v[94:95], v[114:115]
    v_pk_mul_f32 v[96:97], v[96:97], v[116:117]
    v_pk_mul_f32 v[98:99], v[98:99], v[118:119]
    v_pk_mul_f32 v[100:101], v[100:101], v[112:113]
    v_pk_mul_f32 v[102:103], v[102:103], v[114:115]
    v_pk_mul_f32 v[104:105], v[104:105], v[116:117]
    v_pk_mul_f32 v[106:107], v[106:107], v[118:119]
    v_pk_add_f32 v[28:29], v[92:93], v[96:97]
    v_pk_add_f32 v[36:37], v[92:93], v[96:97] neg_lo:[0,1] neg_hi:[0,1]
    v_pk_add_f32 v[32:33], v[100:101], v[104:105]
    v_pk_add_f32 v[40:41], v[100:101], v[104:105] neg_lo:[0,1] neg_hi:[0,1]
    v_pk_add_f32 v[30:31], v[94:95], v[98:99]
    v_pk_add_f32 v[38:39], v[94:95], v[98:99] neg_lo:[0,1] neg_hi:[0,1]
    v_pk_add_f32 v[34:35], v[102:103], v[106:107]
    v_pk_add_f32 v[42:43], v[102:103], v[106:107] neg_lo:[0,1] neg_hi:[0,1]
    v_pk_add_f32 v[44:45], v[28:29], v[30:31]
    v_pk_add_f32 v[46:47], v[32:33], v[34:35]
    v_pk_add_f32 v[48:49], v[28:29], v[30:31] neg_lo:[0,1] neg_hi:[0,1]
    v_pk_add_f32 v[50:51], v[32:33], v[34:35] neg_lo:[0,1] neg_hi:[0,1]
    v_add_f32 v60, v44, v45
    v_add_f32 v68, v46, v47
    v_sub_f32 v64, v44, v45
    v_sub_f32 v72, v46, v47
    v_add_f32 v62, v48, v51
    v_sub_f32 v70, v50, v49
    v_sub_f32 v66, v48, v51
    v_add_f32 v74, v50, v49
    v_add_f32 v52, v36, v42
    v_sub_f32 v53, v40, v38
    v_sub_f32 v54, v36, v42
    v_add_f32 v55, v40, v38
    v_sub_f32 v56, v37, v39
    v_add_f32 v57, v41, v43
    v_add_f32 v58, v37, v39
    v_sub_f32 v59, v41, v43
    v_add_f32 v76, v56, v57
    v_sub_f32 v77, v59, v58
    v_add_f32 v78, v58, v59
    v_sub_f32 v79, v57, v56
    s_mov_b32 s75, 0x3f3504f3
    v_fma_f32 v61, s75, v76, v52
    v_fma_f32 v65, -s75, v76, v52
    v_fma_f32 v69, s75, v77, v53
    v_fma_f32 v73, -s75, v77, v53
    v_fma_f32 v63, s75, v79, v54
    v_fma_f32 v67, -s75, v79, v54
    v_fma_f32 v71, -s75, v78, v55
    v_fma_f32 v75, s75, v78, v55
    v_cvt_pk_bf16_f32 v80, v60, v68
    v_cvt_pk_bf16_f32 v81, v61, v69
    v_cvt_pk_bf16_f32 v82, v62, v70
    v_cvt_pk_bf16_f32 v83, v63, v71
    v_cvt_pk_bf16_f32 v84, v64, v72
    v_cvt_pk_bf16_f32 v85, v65, v73
    v_cvt_pk_bf16_f32 v86, v66, v74
    v_cvt_pk_bf16_f32 v87, v67, v75
    v_mov_b32 v76, 0x80000000
    v_xor_b32 v88, v76, v80
    v_xor_b32 v89, v76, v81
    v_xor_b32 v90, v76, v82
    v_xor_b32 v91, v76, v83
    v_xor_b32 v92, v76, v84
    v_xor_b32 v93, v76, v85
    v_xor_b32 v94, v76, v86
    v_xor_b32 v95, v76, v87
    s_nop 0
    v_permlane32_swap_b32 v80, v82
    v_permlane32_swap_b32 v81, v83
    v_permlane32_swap_b32 v84, v86
    v_permlane32_swap_b32 v85, v87
    v_permlane32_swap_b32 v88, v90
    v_permlane32_swap_b32 v89, v91
    v_permlane32_swap_b32 v92, v94
    v_permlane32_swap_b32 v93, v95
    v_permlane16_swap_b32 v80, v81
    v_permlane16_swap_b32 v82, v83
    v_permlane16_swap_b32 v84, v85
    v_permlane16_swap_b32 v86, v87
    v_permlane16_swap_b32 v88, v89
    v_permlane16_swap_b32 v90, v91
    v_permlane16_swap_b32 v92, v93
    v_permlane16_swap_b32 v94, v95
    s_mov_b32 s54, 0x200000
    buffer_store_dwordx4 v[80:83], v22, s[28:31], 0 offen sc1
    buffer_store_dwordx4 v[84:87], v22, s[28:31], s54 offen sc1
    buffer_store_dwordx4 v[88:91], v23, s[28:31], 0 offen sc1
    buffer_store_dwordx4 v[92:95], v27, s[28:31], 0 offen sc1
    s_lshl_b32 s54, s50, 12
    s_lshl_b32 s55, s51, 11
    s_add_u32 s54, s54, s55
    s_add_u32 s54, s54, 8192
    v_add_u32 v4, s54, v1
    v_add_u32 v5, 0x10000, v4
    ds_write_b128 v4, v[184:187] offset:0
    ds_write_b128 v4, v[188:191] offset:1024
    ds_write_b128 v4, v[192:195] offset:16384
    ds_write_b128 v4, v[196:199] offset:17408
    ds_write_b128 v4, v[200:203] offset:32768
    ds_write_b128 v4, v[204:207] offset:33792
    ds_write_b128 v4, v[208:211] offset:49152
    ds_write_b128 v4, v[212:215] offset:50176
    ds_write_b128 v5, v[216:219] offset:0
    ds_write_b128 v5, v[220:223] offset:1024
    ds_write_b128 v5, v[224:227] offset:16384
    ds_write_b128 v5, v[228:231] offset:17408
    ds_write_b128 v5, v[232:235] offset:32768
    ds_write_b128 v5, v[236:239] offset:33792
    ds_write_b128 v5, v[240:243] offset:49152
    ds_write_b128 v5, v[244:247] offset:50176
    s_waitcnt lgkmcnt(0)
    s_lshr_b32 s54, s13, 1
    v_and_b32 v5, 3, v0
    v_mov_b32 v4, s54
    s_sub_u32 s55, 7, s54
    v_mov_b32 v6, s55
    v_cmp_eq_u32 vcc, 1, v5
    s_nop 1
    v_cndmask_b32 v4, v4, v6, vcc
    s_add_u32 s55, s54, 1
    v_mov_b32 v6, s55
    v_cmp_eq_u32 vcc, 2, v5
    s_nop 1
    v_cndmask_b32 v4, v4, v6, vcc
    v_lshrrev_b32 v6, 2, v0
    v_lshl_add_u32 v4, v6, 3, v4
    v_lshlrev_b32 v4, 3, v4
    v_add_u32 v4, s11, v4
    v_lshlrev_b32 v4, 7, v4
    v_add_u32 v4, 0x250a000, v4
    s_lshr_b32 s55, s2, 4
    s_lshl_b32 s55, s55, 7
    s_add_u32 s55, s55, 0x2507000
    v_writelane_b32 v4, s55, 3
    s_and_b32 s56, s13, 1
    s_cmp_eq_u32 s13, 7
    s_cselect_b32 s56, 0, s56
    s_lshl_b32 s56, s56, 2
    s_or_b32 s56, s56, 3
    s_mul_i32 s56, s56, 0x11111111
    s_or_b32 s56, s56, 8
    s_mov_b32 s57, 0
    v_mov_b32 v6, 0
    v_mov_b32 v7, 8
    s_waitcnt vmcnt(0)
    s_cmp_lg_u32 s10, 0
    s_cbranch_scc1 polls_21
    s_cmp_lg_u32 s73, 0
    s_cbranch_scc1 polls_21
    s_mov_b64 exec, 0x1
    s_mov_b32 s74, 0
poll_19:
    global_load_dword v2, v6, s[96:97] sc1
    s_add_u32 s74, s74, 1
    s_waitcnt vmcnt(0)
    v_cmp_gt_u32 vcc, v7, v2
    s_cbranch_vccz polld_20
    s_cmp_lt_u32 s74, 40000
    s_cbranch_scc1 poll_19
    s_mov_b32 s73, 1
polld_20:
    s_mov_b64 exec, -1
polls_21:
    s_barrier
    s_waitcnt vmcnt(0)
    s_barrier
    s_cmp_lg_u32 s10, 0
    s_cbranch_scc1 sig_22
    s_mov_b64 exec, s[56:57]
    v_mov_b32 v2, 1
    global_atomic_add v4, v2, s[4:5] sc1
    s_mov_b64 exec, -1
sig_22:
    s_mov_b32 s72, 0
layer_loop:
    s_mul_i32 s40, s72, 0x400000
    s_add_u32 s40, s40, 0x600000
    s_mul_i32 s41, s72, -1
    s_add_u32 s41, s41, 0x1
    s_mov_b32 s42, 0x200000
    s_mul_i32 s43, s72, 0x400000
    s_add_u32 s43, s43, 0x0
    s_mul_i32 s44, s72, 0x80000
    s_add_u32 s44, s44, 0x2440000
    s_mul_i32 s45, s72, 0x10000
    s_add_u32 s45, s45, 0x250a000
    s_mul_i32 s46, s72, 0x800
    s_add_u32 s46, s46, 0x2504000
    s_and_b32 s13, s12, 7
    s_lshr_b32 s14, s12, 3
    s_and_b32 s50, s10, 1
    s_lshr_b32 s51, s10, 1
    s_lshl_b32 s36, s13, 1
    s_add_u32 s52, s36, s50
    s_lshl_b32 s37, s11, 3
    s_lshl_b32 s38, s14, 1
    s_add_u32 s37, s37, s38
    s_add_u32 s53, s37, s51
    s_lshl_b32 s54, s53, 15
    s_lshl_b32 s55, s52, 11
    s_add_u32 s54, s54, s55
    v_add_u32 v17, s54, v1
    v_and_b32 v19, 31, v0
    v_lshrrev_b32 v20, 4, v19
    v_lshlrev_b32 v20, 2, v20
    v_and_b32 v18, 3, v19
    v_add_u32 v18, v18, v20
    v_lshlrev_b32 v18, 8, v18
    v_bfe_u32 v20, v19, 2, 2
    v_lshl_add_u32 v18, v20, 3, v18
    s_and_b32 s55, s53, 7
    s_lshl_b32 s55, s55, 5
    s_add_u32 s55, s55, s11
    v_add_u32 v18, s55, v18
    v_lshlrev_b32 v18, 10, v18
    v_lshrrev_b32 v20, 5, v0
    v_lshl_add_u32 v18, v20, 4, v18
    s_lshl_b32 s55, s52, 6
    v_add_u32 v18, s55, v18
    s_lshl_b32 s54, s53, 12
    s_lshl_b32 s55, s52, 8
    s_add_u32 s54, s54, s55
    v_lshlrev_b32 v16, 3, v19
    v_add_u32 v16, s54, v16
    s_cmp_eq_u32 s41, 0
    s_cselect_b64 vcc, -1, 0
    s_cselect_b32 s56, 1024, 32
    v_cndmask_b32 v12, v18, v17, vcc
    v_add_u32 v13, s56, v12
    v_mov_b32 v14, v17
    v_add_u32 v15, 1024, v17
    s_add_u32 s20, s4, s42
    s_addc_u32 s21, s5, 0
    s_cmp_eq_u32 s41, 0
    s_cselect_b32 s20, s20, s6
    s_cselect_b32 s21, s21, s7
    s_mov_b32 s22, 0x200000
    s_mov_b32 s23, 0x20000
    buffer_load_dwordx4 v[108:111], v12, s[20:23], 0 offen sc1
    buffer_load_dwordx4 v[112:115], v13, s[20:23], 0 offen sc1
    s_lshl_b32 s54, s50, 12
    v_add_u32 v8, s54, v1
    s_lshl_b32 s54, s51, 12
    s_add_u32 s54, s54, 8192
    v_add_u32 v9, s54, v1
    v_add_u32 v10, 0x10000, v8
    v_add_u32 v11, 0x10000, v9
    s_lshl_b32 s54, s11, 19
    s_add_u32 s54, s54, s40
    s_add_u32 s16, s4, s54
    s_addc_u32 s17, s5, 0
    s_mov_b32 s18, 0x80000
    s_mov_b32 s19, 0x20000
    s_lshl_b32 s54, s52, 15
    v_add_u32 v21, s54, v1
    v_and_b32 v22, 31, v0
    v_cmp_eq_u32 vcc, 0, v22
    v_subrev_u32 v23, 16, v21
    s_sub_u32 s55, s54, 32768
    s_add_u32 s55, s55, 496
    s_cmp_eq_u32 s52, 0
    s_cselect_b32 s55, 0x7ff00000, s55
    v_and_b32 v22, 32, v0
    v_lshlrev_b32 v22, 4, v22
    v_add_u32 v22, s55, v22
    v_cndmask_b32 v23, v23, v22, vcc
    s_cmp_lt_u32 s52, 8
    s_cselect_b64 vcc, -1, 0
    v_cndmask_b32 v21, v21, v23, vcc
    s_add_u32 s28, s4, s44
    s_addc_u32 s29, s5, 0
    s_mov_b32 s30, 0x40000
    s_mov_b32 s31, 0x20000
    s_lshl_b32 s33, s50, 12
    s_lshl_b32 s55, s51, 11
    s_add_u32 s33, s33, s55
    v_mov_b32 v92, 0
    v_mov_b32 v93, 0
    v_mov_b32 v94, 0
    v_mov_b32 v95, 0
    v_mov_b32 v96, 0
    v_mov_b32 v97, 0
    v_mov_b32 v98, 0
    v_mov_b32 v99, 0
    v_mov_b32 v100, 0
    v_mov_b32 v101, 0
    v_mov_b32 v102, 0
    v_mov_b32 v103, 0
    v_mov_b32 v104, 0
    v_mov_b32 v105, 0
    v_mov_b32 v106, 0
    v_mov_b32 v107, 0
    s_lshl_b32 s54, s11, 3
    s_add_u32 s54, s54, s13
    s_lshl_b32 s54, s54, 10
    s_add_u32 s54, s54, s45
    v_lshlrev_b32 v4, 7, v0
    v_add_u32 v4, s54, v4
    s_sub_u32 s54, s13, 1
    s_cmp_lt_u32 s54, 3
    s_cselect_b32 s54, 12, 8
    v_mov_b32 v5, s54
    s_cmp_eq_u32 s72, 0
    s_cbranch_scc1 g2_23
    s_lshr_b32 s34, s12, 3
    s_lshl_b32 s34, s34, 1
    s_lshl_b32 s35, s11, 3
    s_add_u32 s34, s34, s35
    s_and_b32 s35, s10, 1
    s_add_u32 s34, s34, s35
    s_lshl_b32 s34, s34, 15
    s_add_u32 s34, s34, 0xe00000
    s_add_u32 s24, s4, s34
    s_addc_u32 s25, s5, 0
    s_mov_b32 s26, 0x8000
    s_mov_b32 s27, 0x20000
    s_lshl_b32 s34, s35, 12
    s_lshr_b32 s35, s10, 1
    s_lshl_b32 s35, s35, 11
    s_add_u32 s34, s34, s35
    s_add_u32 m0, s34, 73728
    s_add_u32 s32, s35, 16384
    buffer_load_dwordx4 v1, s[24:27], s32 offen offset:0 lds
    buffer_load_dwordx4 v1, s[24:27], s32 offen offset:1024 lds
    s_add_u32 m0, s34, 90112
    s_add_u32 s32, s35, 20480
    buffer_load_dwordx4 v1, s[24:27], s32 offen offset:0 lds
    buffer_load_dwordx4 v1, s[24:27], s32 offen offset:1024 lds
    s_add_u32 m0, s34, 106496
    s_add_u32 s32, s35, 24576
    buffer_load_dwordx4 v1, s[24:27], s32 offen offset:0 lds
    buffer_load_dwordx4 v1, s[24:27], s32 offen offset:1024 lds
    s_add_u32 m0, s34, 122880
    s_add_u32 s32, s35, 28672
    buffer_load_dwordx4 v1, s[24:27], s32 offen offset:0 lds
    buffer_load_dwordx4 v1, s[24:27], s32 offen offset:1024 lds
g2_23:
    s_cmp_lg_u32 s10, 0
    s_cbranch_scc1 polls_26
    s_cmp_lg_u32 s73, 0
    s_cbranch_scc1 polls_26
    s_mov_b64 exec, 0xff
    s_mov_b32 s74, 0
poll_24:
    global_load_dword v2, v4, s[4:5] sc1
    s_add_u32 s74, s74, 1
    s_waitcnt vmcnt(0)
    v_cmp_gt_u32 vcc, v5, v2
    s_cbranch_vccz polld_25
    s_cmp_lt_u32 s74, 40000
    s_cbranch_scc1 poll_24
    s_mov_b32 s73, 1
polld_25:
    s_mov_b64 exec, -1
polls_26:
    s_cmp_lg_u32 s72, 0
    s_cbranch_scc1 warm_ret
    s_cmp_eq_u32 s10, 1
    s_cbranch_scc1 warm_chain_1
    s_cmp_eq_u32 s10, 2
    s_cbranch_scc1 warm_chain_2
    s_cmp_eq_u32 s10, 3
    s_cbranch_scc1 warm_ret
warm_ret:
    s_barrier
    s_add_u32 s24, s4, s43
    s_addc_u32 s25, s5, 0
    s_mov_b32 s26, 0x200000
    s_mov_b32 s27, 0x20000
    s_add_u32 m0, s33, 0
    s_add_u32 s32, s55, 0
    buffer_load_dwordx4 v21, s[16:19], s32 offen offset:0 sc1 lds
    buffer_load_dwordx4 v21, s[16:19], s32 offen offset:1024 sc1 lds
    s_add_u32 m0, s33, 16384
    s_add_u32 s32, s55, 4096
    buffer_load_dwordx4 v21, s[16:19], s32 offen offset:0 sc1 lds
    buffer_load_dwordx4 v21, s[16:19], s32 offen offset:1024 sc1 lds
    s_add_u32 m0, s33, 32768
    s_add_u32 s32, s55, 8192
    buffer_load_dwordx4 v21, s[16:19], s32 offen offset:0 sc1 lds
    buffer_load_dwordx4 v21, s[16:19], s32 offen offset:1024 sc1 lds
    s_add_u32 m0, s33, 49152
    s_add_u32 s32, s55, 12288
    buffer_load_dwordx4 v21, s[16:19], s32 offen offset:0 sc1 lds
    buffer_load_dwordx4 v21, s[16:19], s32 offen offset:1024 sc1 lds
    s_waitcnt vmcnt(6)
    s_barrier
    s_add_u32 m0, s33, 65536
    s_add_u32 s32, s55, 16384
    buffer_load_dwordx4 v21, s[16:19], s32 offen offset:0 sc1 lds
    buffer_load_dwordx4 v21, s[16:19], s32 offen offset:1024 sc1 lds
    s_add_u32 m0, s33, 81920
    s_add_u32 s32, s55, 20480
    buffer_load_dwordx4 v21, s[16:19], s32 offen offset:0 sc1 lds
    buffer_load_dwordx4 v21, s[16:19], s32 offen offset:1024 sc1 lds
    ds_read_b128 v[28:31], v8 offset:0
    ds_read_b128 v[44:47], v9 offset:0
    ds_read_b128 v[32:35], v8 offset:1024
    ds_read_b128 v[48:51], v9 offset:1024
    ds_read_b128 v[36:39], v8 offset:2048
    ds_read_b128 v[52:55], v9 offset:2048
    ds_read_b128 v[40:43], v8 offset:3072
    ds_read_b128 v[56:59], v9 offset:3072
    s_waitcnt vmcnt(8)
    s_barrier
    s_waitcnt lgkmcnt(0)
    s_add_u32 m0, s33, 98304
    s_add_u32 s32, s55, 24576
    buffer_load_dwordx4 v21, s[16:19], s32 offen offset:0 sc1 lds
    buffer_load_dwordx4 v21, s[16:19], s32 offen offset:1024 sc1 lds
    s_add_u32 m0, s33, 114688
    s_add_u32 s32, s55, 28672
    buffer_load_dwordx4 v21, s[16:19], s32 offen offset:0 sc1 lds
    buffer_load_dwordx4 v21, s[16:19], s32 offen offset:1024 sc1 lds
    ds_read_b128 v[60:63], v8 offset:16384
    ds_read_b128 v[76:79], v9 offset:16384
    v_mfma_f32_32x32x16_bf16 v[92:107], v[28:31], v[44:47], v[92:107]
    ds_read_b128 v[64:67], v8 offset:17408
    ds_read_b128 v[80:83], v9 offset:17408
    v_mfma_f32_32x32x16_bf16 v[92:107], v[32:35], v[48:51], v[92:107]
    ds_read_b128 v[68:71], v8 offset:18432
    ds_read_b128 v[84:87], v9 offset:18432
    v_mfma_f32_32x32x16_bf16 v[92:107], v[36:39], v[52:55], v[92:107]
    ds_read_b128 v[72:75], v8 offset:19456
    ds_read_b128 v[88:91], v9 offset:19456
    v_mfma_f32_32x32x16_bf16 v[92:107], v[40:43], v[56:59], v[92:107]
    s_waitcnt vmcnt(10)
    s_barrier
    s_waitcnt lgkmcnt(0)
    ds_read_b128 v[28:31], v8 offset:32768
    ds_read_b128 v[44:47], v9 offset:32768
    v_mfma_f32_32x32x16_bf16 v[92:107], v[60:63], v[76:79], v[92:107]
    ds_read_b128 v[32:35], v8 offset:33792
    ds_read_b128 v[48:51], v9 offset:33792
    v_mfma_f32_32x32x16_bf16 v[92:107], v[64:67], v[80:83], v[92:107]
    ds_read_b128 v[36:39], v8 offset:34816
    ds_read_b128 v[52:55], v9 offset:34816
    v_mfma_f32_32x32x16_bf16 v[92:107], v[68:71], v[84:87], v[92:107]
    ds_read_b128 v[40:43], v8 offset:35840
    ds_read_b128 v[56:59], v9 offset:35840
    v_mfma_f32_32x32x16_bf16 v[92:107], v[72:75], v[88:91], v[92:107]
    s_waitcnt vmcnt(8)
    s_barrier
    s_waitcnt lgkmcnt(0)
    ds_read_b128 v[60:63], v8 offset:49152
    ds_read_b128 v[76:79], v9 offset:49152
    v_mfma_f32_32x32x16_bf16 v[92:107], v[28:31], v[44:47], v[92:107]
    ds_read_b128 v[64:67], v8 offset:50176
    ds_read_b128 v[80:83], v9 offset:50176
    v_mfma_f32_32x32x16_bf16 v[92:107], v[32:35], v[48:51], v[92:107]
    ds_read_b128 v[68:71], v8 offset:51200
    ds_read_b128 v[84:87], v9 offset:51200
    v_mfma_f32_32x32x16_bf16 v[92:107], v[36:39], v[52:55], v[92:107]
    ds_read_b128 v[72:75], v8 offset:52224
    ds_read_b128 v[88:91], v9 offset:52224
    v_mfma_f32_32x32x16_bf16 v[92:107], v[40:43], v[56:59], v[92:107]
    s_waitcnt vmcnt(6)
    s_barrier
    s_cmp_lg_u32 s72, 0
    s_cbranch_scc1 cs_27
    v_lshlrev_b32 v4, 7, v0
    v_add_u32 v4, 0x2507000, v4
    v_mov_b32 v5, 16
    s_cmp_lg_u32 s10, 0
    s_cbranch_scc1 polls_30
    s_cmp_lg_u32 s73, 0
    s_cbranch_scc1 polls_30
    s_mov_b64 exec, 0xffff
    s_mov_b32 s74, 0
poll_28:
    global_load_dword v2, v4, s[4:5] sc1
    s_add_u32 s74, s74, 1
    s_waitcnt vmcnt(0)
    v_cmp_gt_u32 vcc, v5, v2
    s_cbranch_vccz polld_29
    s_cmp_lt_u32 s74, 40000
    s_cbranch_scc1 poll_28
    s_mov_b32 s73, 1
polld_29:
    s_mov_b64 exec, -1
polls_30:
    s_barrier
    s_add_u32 s24, s4, s43
    s_addc_u32 s25, s5, 0
    s_mov_b32 s26, 0x200000
    s_mov_b32 s27, 0x20000
cs_27:
    s_waitcnt lgkmcnt(0)
    ds_read_b128 v[28:31], v10 offset:0
    ds_read_b128 v[44:47], v11 offset:0
    v_mfma_f32_32x32x16_bf16 v[92:107], v[60:63], v[76:79], v[92:107]
    ds_read_b128 v[32:35], v10 offset:1024
    ds_read_b128 v[48:51], v11 offset:1024
    v_mfma_f32_32x32x16_bf16 v[92:107], v[64:67], v[80:83], v[92:107]
    ds_read_b128 v[36:39], v10 offset:2048
    ds_read_b128 v[52:55], v11 offset:2048
    v_mfma_f32_32x32x16_bf16 v[92:107], v[68:71], v[84:87], v[92:107]
    ds_read_b128 v[40:43], v10 offset:3072
    ds_read_b128 v[56:59], v11 offset:3072
    v_mfma_f32_32x32x16_bf16 v[92:107], v[72:75], v[88:91], v[92:107]
    s_add_u32 m0, s83, 131072
    s_add_u32 s35, s83, 0
    buffer_load_dwordx4 v1, s[84:87], s35 offen offset:0 lds
    buffer_load_dwordx4 v1, s[84:87], s35 offen offset:1024 lds
    s_waitcnt vmcnt(6)
    s_barrier
    s_waitcnt lgkmcnt(0)
    ds_read_b128 v[60:63], v10 offset:16384
    ds_read_b128 v[76:79], v11 offset:16384
    v_mfma_f32_32x32x16_bf16 v[92:107], v[28:31], v[44:47], v[92:107]
    ds_read_b128 v[64:67], v10 offset:17408
    ds_read_b128 v[80:83], v11 offset:17408
    v_mfma_f32_32x32x16_bf16 v[92:107], v[32:35], v[48:51], v[92:107]
    ds_read_b128 v[68:71], v10 offset:18432
    ds_read_b128 v[84:87], v11 offset:18432
    v_mfma_f32_32x32x16_bf16 v[92:107], v[36:39], v[52:55], v[92:107]
    ds_read_b128 v[72:75], v10 offset:19456
    ds_read_b128 v[88:91], v11 offset:19456
    v_mfma_f32_32x32x16_bf16 v[92:107], v[40:43], v[56:59], v[92:107]
    buffer_load_dwordx4 v1, s[84:87], s35 offen offset:2048 lds
    buffer_load_dwordx4 v1, s[84:87], s35 offen offset:3072 lds
    s_waitcnt vmcnt(6)
    s_barrier
    s_waitcnt lgkmcnt(0)
    ds_read_b128 v[28:31], v10 offset:32768
    ds_read_b128 v[44:47], v11 offset:32768
    v_mfma_f32_32x32x16_bf16 v[92:107], v[60:63], v[76:79], v[92:107]
    ds_read_b128 v[32:35], v10 offset:33792
    ds_read_b128 v[48:51], v11 offset:33792
    v_mfma_f32_32x32x16_bf16 v[92:107], v[64:67], v[80:83], v[92:107]
    ds_read_b128 v[36:39], v10 offset:34816
    ds_read_b128 v[52:55], v11 offset:34816
    v_mfma_f32_32x32x16_bf16 v[92:107], v[68:71], v[84:87], v[92:107]
    ds_read_b128 v[40:43], v10 offset:35840
    ds_read_b128 v[56:59], v11 offset:35840
    v_mfma_f32_32x32x16_bf16 v[92:107], v[72:75], v[88:91], v[92:107]
    s_add_u32 m0, s83, 135168
    s_add_u32 s35, s83, 4096
    buffer_load_dwordx4 v1, s[84:87], s35 offen offset:0 lds
    buffer_load_dwordx4 v1, s[84:87], s35 offen offset:1024 lds
    s_waitcnt vmcnt(6)
    s_barrier
    s_waitcnt lgkmcnt(0)
    ds_read_b128 v[60:63], v10 offset:49152
    ds_read_b128 v[76:79], v11 offset:49152
    v_mfma_f32_32x32x16_bf16 v[92:107], v[28:31], v[44:47], v[92:107]
    ds_read_b128 v[64:67], v10 offset:50176
    ds_read_b128 v[80:83], v11 offset:50176
    v_mfma_f32_32x32x16_bf16 v[92:107], v[32:35], v[48:51], v[92:107]
    ds_read_b128 v[68:71], v10 offset:51200
    ds_read_b128 v[84:87], v11 offset:51200
    v_mfma_f32_32x32x16_bf16 v[92:107], v[36:39], v[52:55], v[92:107]
    ds_read_b128 v[72:75], v10 offset:52224
    ds_read_b128 v[88:91], v11 offset:52224
    v_mfma_f32_32x32x16_bf16 v[92:107], v[40:43], v[56:59], v[92:107]
    buffer_load_dwordx4 v1, s[84:87], s35 offen offset:2048 lds
    buffer_load_dwordx4 v1, s[84:87], s35 offen offset:3072 lds
    s_waitcnt lgkmcnt(0)
    v_mfma_f32_32x32x16_bf16 v[92:107], v[60:63], v[76:79], v[92:107]
    v_mfma_f32_32x32x16_bf16 v[92:107], v[64:67], v[80:83], v[92:107]
    v_mfma_f32_32x32x16_bf16 v[92:107], v[68:71], v[84:87], v[92:107]
    v_mfma_f32_32x32x16_bf16 v[92:107], v[72:75], v[88:91], v[92:107]
    s_cmp_lg_u32 s72, 0
    s_cbranch_scc1 gt_31
    s_lshl_b32 s54, s13, 14
    s_lshl_b32 s55, s50, 12
    s_add_u32 s54, s54, s55
    s_lshl_b32 s55, s51, 11
    s_add_u32 s54, s54, s55
    s_add_u32 s54, s54, 8192
    v_add_u32 v4, s54, v1
    ds_read_b128 v[116:119], v4
    ds_read_b128 v[120:123], v4 offset:1024
    s_lshl_b32 s56, s14, 1
    s_lshl_b32 s57, s11, 3
    s_add_u32 s56, s56, s57
    s_add_u32 s56, s56, s50
    s_lshl_b32 s56, s56, 15
    s_lshl_b32 s57, s13, 12
    s_add_u32 s56, s56, s57
    s_add_u32 s56, s56, s55
    s_add_u32 s16, s4, 0xe00000
    s_addc_u32 s17, s5, 0
    s_mov_b32 s18, 0x200000
    s_mov_b32 s19, 0x20000
    s_waitcnt lgkmcnt(0)
    buffer_store_dwordx4 v[116:119], v1, s[16:19], s56 offen sc1
    buffer_store_dwordx4 v[120:123], v1, s[16:19], s56 offen offset:1024 sc1
gt_31:
    s_barrier
    v_permlane32_swap_b32 v108, v110
    v_permlane32_swap_b32 v109, v111
    v_permlane32_swap_b32 v112, v114
    v_permlane32_swap_b32 v113, v115
    v_lshlrev_b32 v28, 16, v108
    v_and_b32 v29, 0xffff0000, v108
    v_lshlrev_b32 v30, 16, v109
    v_and_b32 v31, 0xffff0000, v109
    v_lshlrev_b32 v32, 16, v110
    v_and_b32 v33, 0xffff0000, v110
    v_lshlrev_b32 v34, 16, v111
    v_and_b32 v35, 0xffff0000, v111
    v_lshlrev_b32 v36, 16, v112
    v_and_b32 v37, 0xffff0000, v112
    v_lshlrev_b32 v38, 16, v113
    v_and_b32 v39, 0xffff0000, v113
    v_lshlrev_b32 v40, 16, v114
    v_and_b32 v41, 0xffff0000, v114
    v_lshlrev_b32 v42, 16, v115
    v_and_b32 v43, 0xffff0000, v115
    v_pk_add_f32 v[92:93], v[92:93], v[28:29]
    v_pk_add_f32 v[94:95], v[94:95], v[30:31]
    v_pk_add_f32 v[96:97], v[96:97], v[32:33]
    v_pk_add_f32 v[98:99], v[98:99], v[34:35]
    v_pk_add_f32 v[100:101], v[100:101], v[36:37]
    v_pk_add_f32 v[102:103], v[102:103], v[38:39]
    v_pk_add_f32 v[104:105], v[104:105], v[40:41]
    v_pk_add_f32 v[106:107], v[106:107], v[42:43]
    v_cvt_pk_bf16_f32 v60, v92, v93
    v_cvt_pk_bf16_f32 v61, v94, v95
    v_cvt_pk_bf16_f32 v62, v96, v97
    v_cvt_pk_bf16_f32 v63, v98, v99
    v_cvt_pk_bf16_f32 v64, v100, v101
    v_cvt_pk_bf16_f32 v65, v102, v103
    v_cvt_pk_bf16_f32 v66, v104, v105
    v_cvt_pk_bf16_f32 v67, v106, v107
    v_pk_add_f32 v[68:69], v[92:93], v[94:95]
    v_pk_mul_f32 v[70:71], v[92:93], v[92:93]
    v_permlane32_swap_b32 v60, v62
    v_permlane32_swap_b32 v61, v63
    v_permlane32_swap_b32 v64, v66
    v_permlane32_swap_b32 v65, v67
    v_pk_fma_f32 v[70:71], v[94:95], v[94:95], v[70:71]
    buffer_store_dwordx4 v[60:63], v14, s[24:27], 0 offen sc1
    buffer_store_dwordx4 v[64:67], v15, s[24:27], 0 offen sc1
    v_pk_add_f32 v[68:69], v[68:69], v[96:97]
    v_pk_fma_f32 v[70:71], v[96:97], v[96:97], v[70:71]
    v_pk_add_f32 v[68:69], v[68:69], v[98:99]
    v_pk_fma_f32 v[70:71], v[98:99], v[98:99], v[70:71]
    v_pk_add_f32 v[68:69], v[68:69], v[100:101]
    v_pk_fma_f32 v[70:71], v[100:101], v[100:101], v[70:71]
    v_pk_add_f32 v[68:69], v[68:69], v[102:103]
    v_pk_fma_f32 v[70:71], v[102:103], v[102:103], v[70:71]
    v_pk_add_f32 v[68:69], v[68:69], v[104:105]
    v_pk_fma_f32 v[70:71], v[104:105], v[104:105], v[70:71]
    v_pk_add_f32 v[68:69], v[68:69], v[106:107]
    v_pk_fma_f32 v[70:71], v[106:107], v[106:107], v[70:71]
    v_add_f32 v72, v68, v69
    v_add_f32 v73, v70, v71
    v_mov_b32 v74, v72
    v_mov_b32 v75, v73
    s_nop 1
    v_permlane32_swap_b32 v72, v74
    v_permlane32_swap_b32 v73, v75
    s_nop 0
    v_add_f32 v72, v72, v74
    v_add_f32 v73, v73, v75
    s_mov_b64 exec, 0xffffffff
    buffer_store_dwordx2 v[72:73], v16, s[28:31], 0 offen sc1
    s_mov_b64 exec, -1
    s_add_u32 m0, s83, 0
    s_add_u32 s35, s83, 32768
    buffer_load_dwordx4 v1, s[84:87], s35 offen offset:0 lds
    buffer_load_dwordx4 v1, s[84:87], s35 offen offset:1024 lds
    buffer_load_dwordx4 v1, s[84:87], s35 offen offset:2048 lds
    buffer_load_dwordx4 v1, s[84:87], s35 offen offset:3072 lds
    s_add_u32 m0, s83, 4096
    s_add_u32 s35, s83, 36864
    buffer_load_dwordx4 v1, s[84:87], s35 offen offset:0 lds
    buffer_load_dwordx4 v1, s[84:87], s35 offen offset:1024 lds
    buffer_load_dwordx4 v1, s[84:87], s35 offen offset:2048 lds
    buffer_load_dwordx4 v1, s[84:87], s35 offen offset:3072 lds
    s_lshl_b32 s54, s11, 1
    s_lshr_b32 s55, s14, 1
    s_add_u32 s54, s54, s55
    s_lshl_b32 s54, s54, 7
    s_add_u32 s54, s54, s46
    v_mov_b32 v4, s54
    s_waitcnt vmcnt(8)
    s_barrier
    s_cmp_lg_u32 s10, 0
    s_cbranch_scc1 sig_33
    s_mov_b64 exec, 1
    v_mov_b32 v2, 1
    global_atomic_add v4, v2, s[4:5] sc1
    s_mov_b64 exec, -1
sig_33:
    s_mul_i32 s40, s72, 0x400000
    s_add_u32 s40, s40, 0x0
    s_mul_i32 s42, s72, 0x80000
    s_add_u32 s42, s42, 0x2440000
    s_mul_i32 s43, s72, 0x700000
    s_add_u32 s43, s43, 0x1600000
    s_mul_i32 s44, s72, 0x800
    s_add_u32 s44, s44, 0x2504000
    s_mul_i32 s45, s72, 0x800
    s_add_u32 s45, s45, 0x2505000
    s_mul_i32 s46, s72, 0x800
    s_add_u32 s46, s46, 0x2508800
    v_and_b32 v6, 31, v0
    v_lshrrev_b32 v7, 5, v0
    s_cmp_lg_u32 s72, 0
    s_cbranch_scc1 l0_34
    s_lshl_b32 s33, s88, 11
    s_add_u32 s33, s33, 0x2400000
    s_add_u32 s24, s4, s33
    s_addc_u32 s25, s5, 0
    s_mov_b32 s26, 0x3800
    s_mov_b32 s27, 0x20000
    s_lshl_b32 s39, s10, 11
    buffer_load_dwordx4 v[16:19], v1, s[24:27], s39 offen
    buffer_load_dwordx4 v[20:23], v1, s[24:27], s39 offen offset:1024
    s_lshl_b32 s39, s10, 11
    s_add_u32 s39, s39, 8192
    buffer_load_dwordx4 v[24:27], v1, s[24:27], s39 offen
    buffer_load_dwordx4 v[28:31], v1, s[24:27], s39 offen offset:1024
l0_34:
    v_and_b32 v6, 31, v0
    v_lshrrev_b32 v7, 5, v0
    s_lshl_b32 s14, s89, 2
    s_add_u32 s14, s14, s10
    s_lshl_b32 s33, s14, 15
    s_add_u32 s33, s33, s40
    s_add_u32 s20, s4, s33
    s_addc_u32 s21, s5, 0
    s_mov_b32 s22, 0x8000
    s_mov_b32 s23, 0x20000
    s_lshl_b32 s33, s14, 12
    s_add_u32 s33, s33, s42
    s_add_u32 s28, s4, s33
    s_addc_u32 s29, s5, 0
    s_mov_b32 s30, 0x1000
    s_mov_b32 s31, 0x20000
    s_mul_i32 s33, s14, 112
    s_add_u32 s33, s33, s88
    s_lshl_b32 s33, s33, 10
    s_add_u32 s33, s33, s43
    s_add_u32 s48, s4, s33
    s_addc_u32 s49, s5, 0
    s_mov_b32 s50, 0x1c00
    s_mov_b32 s51, 0x20000
    s_movk_i32 s38, 4096
    v_lshlrev_b32 v7, 11, v7
    v_lshl_add_u32 v6, v6, 3, v7
    v_add_u32 v3, 0x10000, v1
    v_add_u32 v13, 0x20000, v1
    s_lshl_b32 s54, s89, 7
    s_add_u32 s54, s54, s44
    v_mov_b32 v10, s54
    v_mov_b32 v11, 16
    s_add_u32 m0, s83, 32768
    s_add_u32 s35, s83, 65536
    buffer_load_dwordx4 v1, s[84:87], s35 offen offset:0 lds
    buffer_load_dwordx4 v1, s[84:87], s35 offen offset:1024 lds
    buffer_load_dwordx4 v1, s[84:87], s35 offen offset:2048 lds
    buffer_load_dwordx4 v1, s[84:87], s35 offen offset:3072 lds
    s_add_u32 m0, s83, 36864
    s_add_u32 s35, s83, 69632
    buffer_load_dwordx4 v1, s[84:87], s35 offen offset:0 lds
    buffer_load_dwordx4 v1, s[84:87], s35 offen offset:1024 lds
    buffer_load_dwordx4 v1, s[84:87], s35 offen offset:2048 lds
    buffer_load_dwordx4 v1, s[84:87], s35 offen offset:3072 lds
    s_add_u32 m0, s83, 65536
    s_add_u32 s35, s83, 98304
    buffer_load_dwordx4 v1, s[84:87], s35 offen offset:0 lds
    buffer_load_dwordx4 v1, s[84:87], s35 offen offset:1024 lds
    buffer_load_dwordx4 v1, s[84:87], s35 offen offset:2048 lds
    buffer_load_dwordx4 v1, s[84:87], s35 offen offset:3072 lds
    s_add_u32 m0, s83, 69632
    s_add_u32 s35, s83, 102400
    buffer_load_dwordx4 v1, s[84:87], s35 offen offset:0 lds
    buffer_load_dwordx4 v1, s[84:87], s35 offen offset:1024 lds
    buffer_load_dwordx4 v1, s[84:87], s35 offen offset:2048 lds
    buffer_load_dwordx4 v1, s[84:87], s35 offen offset:3072 lds
    s_cmp_lg_u32 s72, 0
    s_cbranch_scc1 l0_35
    s_waitcnt vmcnt(16)
    v_pk_add_f32 v[16:17], v[16:17], v[20:21]
    v_pk_add_f32 v[18:19], v[18:19], v[22:23]
    v_pk_add_f32 v[24:25], v[24:25], v[28:29]
    v_pk_add_f32 v[26:27], v[26:27], v[30:31]
    s_nop 1
    v_add_f32_dpp v16, v16, v16 row_ror:8 row_mask:0xf bank_mask:0xf
    v_add_f32_dpp v17, v17, v17 row_ror:8 row_mask:0xf bank_mask:0xf
    v_add_f32_dpp v18, v18, v18 row_ror:8 row_mask:0xf bank_mask:0xf
    v_add_f32_dpp v19, v19, v19 row_ror:8 row_mask:0xf bank_mask:0xf
    v_add_f32_dpp v24, v24, v24 row_ror:8 row_mask:0xf bank_mask:0xf
    v_add_f32_dpp v25, v25, v25 row_ror:8 row_mask:0xf bank_mask:0xf
    v_add_f32_dpp v26, v26, v26 row_ror:8 row_mask:0xf bank_mask:0xf
    v_add_f32_dpp v27, v27, v27 row_ror:8 row_mask:0xf bank_mask:0xf
    v_mov_b32 v20, v16
    v_mov_b32 v21, v17
    v_mov_b32 v22, v18
    v_mov_b32 v23, v19
    v_mov_b32 v28, v24
    v_mov_b32 v29, v25
    v_mov_b32 v30, v26
    v_mov_b32 v31, v27
    s_nop 1
    v_permlane16_swap_b32 v16, v20
    v_permlane16_swap_b32 v17, v21
    v_permlane16_swap_b32 v18, v22
    v_permlane16_swap_b32 v19, v23
    v_permlane16_swap_b32 v24, v28
    v_permlane16_swap_b32 v25, v29
    v_permlane16_swap_b32 v26, v30
    v_permlane16_swap_b32 v27, v31
    s_nop 0
    v_add_f32 v16, v16, v20
    v_add_f32 v17, v17, v21
    v_add_f32 v18, v18, v22
    v_add_f32 v19, v19, v23
    v_add_f32 v24, v24, v28
    v_add_f32 v25, v25, v29
    v_add_f32 v26, v26, v30
    v_add_f32 v27, v27, v31
    v_mov_b32 v20, v16
    v_mov_b32 v21, v17
    v_mov_b32 v22, v18
    v_mov_b32 v23, v19
    v_mov_b32 v28, v24
    v_mov_b32 v29, v25
    v_mov_b32 v30, v26
    v_mov_b32 v31, v27
    s_nop 1
    v_permlane32_swap_b32 v16, v20
    v_permlane32_swap_b32 v17, v21
    v_permlane32_swap_b32 v18, v22
    v_permlane32_swap_b32 v19, v23
    v_permlane32_swap_b32 v24, v28
    v_permlane32_swap_b32 v25, v29
    v_permlane32_swap_b32 v26, v30
    v_permlane32_swap_b32 v27, v31
    s_nop 0
    v_add_f32 v16, v16, v20
    v_add_f32 v17, v17, v21
    v_add_f32 v18, v18, v22
    v_add_f32 v19, v19, v23
    v_add_f32 v24, v24, v28
    v_add_f32 v25, v25, v29
    v_add_f32 v26, v26, v30
    v_add_f32 v27, v27, v31
    s_lshl_b32 s39, s10, 7
    s_add_u32 s39, s39, 98304
    v_add_u32 v8, s39, v1
    s_mov_b64 exec, 0xff
    ds_write_b128 v8, v[16:19] offset:0
    ds_write_b128 v8, v[24:27] offset:512
    s_mov_b64 exec, -1
    s_waitcnt lgkmcnt(0)
l0_35:
    s_cmp_lg_u32 s10, 0
    s_cbranch_scc1 polls_38
    s_cmp_lg_u32 s73, 0
    s_cbranch_scc1 polls_38
    s_mov_b64 exec, 0x1
    s_mov_b32 s74, 0
poll_36:
    global_load_dword v2, v10, s[4:5] sc1
    s_add_u32 s74, s74, 1
    s_waitcnt vmcnt(0)
    v_cmp_gt_u32 vcc, v11, v2
    s_cbranch_vccz polld_37
    s_cmp_lt_u32 s74, 40000
    s_cbranch_scc1 poll_36
    s_mov_b32 s73, 1
polld_37:
    s_mov_b64 exec, -1
polls_38:
    s_barrier
    s_mov_b32 s36, 0
    buffer_load_dwordx4 a[0:3], v1, s[20:23], s36 offen offset:0 sc1
    buffer_load_dwordx4 a[4:7], v1, s[20:23], s36 offen offset:1024 sc1
    buffer_load_dwordx4 a[8:11], v1, s[20:23], s36 offen offset:2048 sc1
    buffer_load_dwordx4 a[12:15], v1, s[20:23], s36 offen offset:3072 sc1
    s_mov_b32 s36, 4096
    buffer_load_dwordx4 a[16:19], v1, s[20:23], s36 offen offset:0 sc1
    buffer_load_dwordx4 a[20:23], v1, s[20:23], s36 offen offset:1024 sc1
    buffer_load_dwordx4 a[24:27], v1, s[20:23], s36 offen offset:2048 sc1
    buffer_load_dwordx4 a[28:31], v1, s[20:23], s36 offen offset:3072 sc1
    s_mov_b32 s36, 8192
    buffer_load_dwordx4 a[32:35], v1, s[20:23], s36 offen offset:0 sc1
    buffer_load_dwordx4 a[36:39], v1, s[20:23], s36 offen offset:1024 sc1
    s_lshl_b32 s54, s89, 7
    s_add_u32 s54, s54, s46
    v_mov_b32 v9, s54
    v_mov_b32 v12, 1
    s_waitcnt vmcnt(10)
    s_barrier
    s_cmp_lg_u32 s72, 0
    s_cbranch_scc1 l0_39
    v_and_b32 v8, 31, v0
    v_lshlrev_b32 v8, 2, v8
    v_add_u32 v8, 98304, v8
    ds_read_b32 v16, v8 offset:0
    ds_read_b32 v20, v8 offset:128
    ds_read_b32 v24, v8 offset:256
    ds_read_b32 v28, v8 offset:384
    ds_read_b32 v32, v8 offset:512
    ds_read_b32 v36, v8 offset:640
    ds_read_b32 v40, v8 offset:768
    v_cmp_gt_u32 vcc, 32, v0
    s_waitcnt lgkmcnt(0)
    v_cvt_pk_bf16_f32 v18, v16, v16
    s_branch warm_over_0
warm_stub_0:
warm_chain_1:
    s_branch warm_stub_1
warm_over_0:
    v_and_b32 v19, 0xffff0000, v18
    v_sub_f32 v19, v16, v19
    v_cvt_pk_bf16_f32 v19, v19, v19
    v_and_b32 v18, 0xffff, v18
    v_lshl_or_b32 v19, v19, 16, v18
    v_cndmask_b32 v226, 0, v19, vcc
    v_cndmask_b32 v227, 0, v18, vcc
    v_mov_b32 v228, 0
    v_mov_b32 v229, 0
    v_cvt_pk_bf16_f32 v22, v20, v20
    v_and_b32 v23, 0xffff0000, v22
    v_sub_f32 v23, v20, v23
    v_cvt_pk_bf16_f32 v23, v23, v23
    v_and_b32 v22, 0xffff, v22
    v_lshl_or_b32 v23, v23, 16, v22
    v_cndmask_b32 v230, 0, v23, vcc
    v_cndmask_b32 v231, 0, v22, vcc
    v_mov_b32 v232, 0
    v_mov_b32 v233, 0
    v_cvt_pk_bf16_f32 v26, v24, v24
    v_and_b32 v27, 0xffff0000, v26
    v_sub_f32 v27, v24, v27
    v_cvt_pk_bf16_f32 v27, v27, v27
    v_and_b32 v26, 0xffff, v26
    v_lshl_or_b32 v27, v27, 16, v26
    v_cndmask_b32 v234, 0, v27, vcc
    v_cndmask_b32 v235, 0, v26, vcc
    v_mov_b32 v236, 0
    v_mov_b32 v237, 0
    v_cvt_pk_bf16_f32 v30, v28, v28
    v_and_b32 v31, 0xffff0000, v30
    v_sub_f32 v31, v28, v31
    v_cvt_pk_bf16_f32 v31, v31, v31
    v_and_b32 v30, 0xffff, v30
    v_lshl_or_b32 v31, v31, 16, v30
    v_cndmask_b32 v238, 0, v31, vcc
    v_cndmask_b32 v239, 0, v30, vcc
    v_mov_b32 v240, 0
    v_mov_b32 v241, 0
    v_cvt_pk_bf16_f32 v34, v32, v32
    v_and_b32 v35, 0xffff0000, v34
    v_sub_f32 v35, v32, v35
    v_cvt_pk_bf16_f32 v35, v35, v35
    v_and_b32 v34, 0xffff, v34
    v_lshl_or_b32 v35, v35, 16, v34
    v_cndmask_b32 v242, 0, v35, vcc
    v_cndmask_b32 v243, 0, v34, vcc
    v_mov_b32 v244, 0
    v_mov_b32 v245, 0
    v_cvt_pk_bf16_f32 v38, v36, v36
    v_and_b32 v39, 0xffff0000, v38
    v_sub_f32 v39, v36, v39
    v_cvt_pk_bf16_f32 v39, v39, v39
    v_and_b32 v38, 0xffff, v38
    v_lshl_or_b32 v39, v39, 16, v38
    v_cndmask_b32 v246, 0, v39, vcc
    v_cndmask_b32 v247, 0, v38, vcc
    v_mov_b32 v248, 0
    v_mov_b32 v249, 0
    v_cvt_pk_bf16_f32 v42, v40, v40
    v_and_b32 v43, 0xffff0000, v42
    v_sub_f32 v43, v40, v43
    v_cvt_pk_bf16_f32 v43, v43, v43
    v_and_b32 v42, 0xffff, v42
    v_lshl_or_b32 v43, v43, 16, v42
    v_cndmask_b32 v250, 0, v43, vcc
    v_cndmask_b32 v251, 0, v42, vcc
    v_mov_b32 v252, 0
    v_mov_b32 v253, 0
l0_39:
    ds_read_b128 v[16:19], v13 offset:0
    ds_read_b128 v[20:23], v1 offset:0
    ds_read_b128 v[24:27], v1 offset:32768
    ds_read_b128 v[28:31], v13 offset:1024
    ds_read_b128 v[32:35], v1 offset:1024
    ds_read_b128 v[36:39], v1 offset:33792
    ds_read_b128 v[40:43], v13 offset:2048
    ds_read_b128 v[44:47], v1 offset:2048
    ds_read_b128 v[48:51], v1 offset:34816
    ds_read_b128 v[52:55], v13 offset:3072
    ds_read_b128 v[56:59], v1 offset:3072
    ds_read_b128 v[60:63], v1 offset:35840
    s_waitcnt lgkmcnt(8)
    s_waitcnt vmcnt(9)
    v_mfma_f32_32x32x16_bf16 v[80:95], v[16:19], a[0:3], 0
    ds_read_b128 v[16:19], v13 offset:4096
    v_mfma_f32_32x32x16_bf16 v[96:111], v[20:23], a[0:3], 0
    buffer_load_dwordx4 a[40:43], v1, s[20:23], s36 offen offset:2048 sc1
    ds_read_b128 v[20:23], v1 offset:4096
    v_mfma_f32_32x32x16_bf16 v[112:127], v[24:27], a[0:3], 0
    buffer_load_dwordx2 v[192:193], v6, s[28:31], 0 offen offset:0 sc1
    ds_read_b128 v[24:27], v1 offset:36864
    s_waitcnt vmcnt(10)
    v_mfma_f32_32x32x16_bf16 v[80:95], v[28:31], a[4:7], v[80:95]
    buffer_load_dwordx4 a[44:47], v1, s[20:23], s36 offen offset:3072 sc1
    ds_read_b128 v[28:31], v13 offset:5120
    s_waitcnt lgkmcnt(8)
    v_mfma_f32_32x32x16_bf16 v[96:111], v[32:35], a[4:7], v[96:111]
    buffer_load_dwordx2 v[194:195], v6, s[28:31], 0 offen offset:256 sc1
    ds_read_b128 v[32:35], v1 offset:5120
    v_mfma_f32_32x32x16_bf16 v[112:127], v[36:39], a[4:7], v[112:127]
    ds_read_b128 v[36:39], v1 offset:37888
    s_waitcnt vmcnt(11)
    v_mfma_f32_32x32x16_bf16 v[80:95], v[40:43], a[8:11], v[80:95]
    s_mov_b32 s36, 12288
    buffer_load_dwordx4 a[48:51], v1, s[20:23], s36 offen offset:0 sc1
    ds_read_b128 v[40:43], v13 offset:6144
    v_mfma_f32_32x32x16_bf16 v[96:111], v[44:47], a[8:11], v[96:111]
    buffer_load_dwordx2 v[196:197], v6, s[28:31], 0 offen offset:512 sc1
    ds_read_b128 v[44:47], v1 offset:6144
    s_waitcnt lgkmcnt(8)
    v_mfma_f32_32x32x16_bf16 v[112:127], v[48:51], a[8:11], v[112:127]
    ds_read_b128 v[48:51], v1 offset:38912
    s_waitcnt vmcnt(12)
    v_mfma_f32_32x32x16_bf16 v[80:95], v[52:55], a[12:15], v[80:95]
    buffer_load_dwordx4 a[52:55], v1, s[20:23], s36 offen offset:1024 sc1
    ds_read_b128 v[52:55], v13 offset:7168
    v_mfma_f32_32x32x16_bf16 v[96:111], v[56:59], a[12:15], v[96:111]
    buffer_load_dwordx2 v[198:199], v6, s[28:31], 0 offen offset:768 sc1
    ds_read_b128 v[56:59], v1 offset:7168
    v_mfma_f32_32x32x16_bf16 v[112:127], v[60:63], a[12:15], v[112:127]
    ds_read_b128 v[60:63], v1 offset:39936
    s_waitcnt lgkmcnt(8)
    s_waitcnt vmcnt(13)
    v_mfma_f32_32x32x16_bf16 v[80:95], v[16:19], a[16:19], v[80:95]
    ds_read_b128 v[16:19], v13 offset:8192
    v_mfma_f32_32x32x16_bf16 v[96:111], v[20:23], a[16:19], v[96:111]
    buffer_load_dwordx4 a[56:59], v1, s[20:23], s36 offen offset:2048 sc1
    ds_read_b128 v[20:23], v1 offset:8192
    v_mfma_f32_32x32x16_bf16 v[112:127], v[24:27], a[16:19], v[112:127]
    buffer_load_dwordx2 v[200:201], v6, s[28:31], 0 offen offset:1024 sc1
    ds_read_b128 v[24:27], v1 offset:40960
    s_waitcnt vmcnt(14)
    v_mfma_f32_32x32x16_bf16 v[80:95], v[28:31], a[20:23], v[80:95]
    buffer_load_dwordx4 a[60:63], v1, s[20:23], s36 offen offset:3072 sc1
    ds_read_b128 v[28:31], v13 offset:9216
    s_waitcnt lgkmcnt(8)
    v_mfma_f32_32x32x16_bf16 v[96:111], v[32:35], a[20:23], v[96:111]
    buffer_load_dwordx2 v[202:203], v6, s[28:31], 0 offen offset:1280 sc1
    ds_read_b128 v[32:35], v1 offset:9216
    v_mfma_f32_32x32x16_bf16 v[112:127], v[36:39], a[20:23], v[112:127]
    ds_read_b128 v[36:39], v1 offset:41984
    s_waitcnt vmcnt(15)
    v_mfma_f32_32x32x16_bf16 v[80:95], v[40:43], a[24:27], v[80:95]
    s_mov_b32 s36, 16384
    buffer_load_dwordx4 a[64:67], v1, s[20:23], s36 offen offset:0 sc1
    ds_read_b128 v[40:43], v13 offset:10240
    v_mfma_f32_32x32x16_bf16 v[96:111], v[44:47], a[24:27], v[96:111]
    buffer_load_dwordx2 v[204:205], v6, s[28:31], 0 offen offset:1536 sc1
    ds_read_b128 v[44:47], v1 offset:10240
    s_waitcnt lgkmcnt(8)
    v_mfma_f32_32x32x16_bf16 v[112:127], v[48:51], a[24:27], v[112:127]
    ds_read_b128 v[48:51], v1 offset:43008
    s_waitcnt vmcnt(16)
    v_mfma_f32_32x32x16_bf16 v[80:95], v[52:55], a[28:31], v[80:95]
    buffer_load_dwordx4 a[68:71], v1, s[20:23], s36 offen offset:1024 sc1
    ds_read_b128 v[52:55], v13 offset:11264
    v_mfma_f32_32x32x16_bf16 v[96:111], v[56:59], a[28:31], v[96:111]
    buffer_load_dwordx2 v[206:207], v6, s[28:31], 0 offen offset:1792 sc1
    ds_read_b128 v[56:59], v1 offset:11264
    v_mfma_f32_32x32x16_bf16 v[112:127], v[60:63], a[28:31], v[112:127]
    ds_read_b128 v[60:63], v1 offset:44032
    s_waitcnt lgkmcnt(8)
    s_waitcnt vmcnt(17)
    v_mfma_f32_32x32x16_bf16 v[80:95], v[16:19], a[32:35], v[80:95]
    ds_read_b128 v[16:19], v13 offset:12288
    v_mfma_f32_32x32x16_bf16 v[96:111], v[20:23], a[32:35], v[96:111]
    buffer_load_dwordx4 a[72:75], v1, s[20:23], s36 offen offset:2048 sc1
    ds_read_b128 v[20:23], v1 offset:12288
    v_mfma_f32_32x32x16_bf16 v[112:127], v[24:27], a[32:35], v[112:127]
    ds_read_b128 v[24:27], v1 offset:45056
    s_waitcnt vmcnt(17)
    v_mfma_f32_32x32x16_bf16 v[80:95], v[28:31], a[36:39], v[80:95]
    buffer_load_dwordx4 a[76:79], v1, s[20:23], s36 offen offset:3072 sc1
    ds_read_b128 v[28:31], v13 offset:13312
    s_waitcnt lgkmcnt(8)
    v_mfma_f32_32x32x16_bf16 v[96:111], v[32:35], a[36:39], v[96:111]
    ds_read_b128 v[32:35], v1 offset:13312
    v_mfma_f32_32x32x16_bf16 v[112:127], v[36:39], a[36:39], v[112:127]
    ds_read_b128 v[36:39], v1 offset:46080
    s_waitcnt vmcnt(17)
    v_mfma_f32_32x32x16_bf16 v[80:95], v[40:43], a[40:43], v[80:95]
    s_mov_b32 s36, 20480
    buffer_load_dwordx4 a[80:83], v1, s[20:23], s36 offen offset:0 sc1
    ds_read_b128 v[40:43], v13 offset:14336
    v_mfma_f32_32x32x16_bf16 v[96:111], v[44:47], a[40:43], v[96:111]
    ds_read_b128 v[44:47], v1 offset:14336
    s_waitcnt lgkmcnt(8)
    v_mfma_f32_32x32x16_bf16 v[112:127], v[48:51], a[40:43], v[112:127]
    ds_read_b128 v[48:51], v1 offset:47104
    s_waitcnt vmcnt(16)
    v_mfma_f32_32x32x16_bf16 v[80:95], v[52:55], a[44:47], v[80:95]
    buffer_load_dwordx4 a[84:87], v1, s[20:23], s36 offen offset:1024 sc1
    ds_read_b128 v[52:55], v13 offset:15360
    v_mfma_f32_32x32x16_bf16 v[96:111], v[56:59], a[44:47], v[96:111]
    ds_read_b128 v[56:59], v1 offset:15360
    v_mfma_f32_32x32x16_bf16 v[112:127], v[60:63], a[44:47], v[112:127]
    ds_read_b128 v[60:63], v1 offset:48128
    s_waitcnt lgkmcnt(8)
    s_waitcnt vmcnt(15)
    v_mfma_f32_32x32x16_bf16 v[80:95], v[16:19], a[48:51], v[80:95]
    ds_read_b128 v[16:19], v13 offset:16384
    v_mfma_f32_32x32x16_bf16 v[96:111], v[20:23], a[48:51], v[96:111]
    buffer_load_dwordx4 a[88:91], v1, s[20:23], s36 offen offset:2048 sc1
    ds_read_b128 v[20:23], v1 offset:16384
    v_mfma_f32_32x32x16_bf16 v[112:127], v[24:27], a[48:51], v[112:127]
    ds_read_b128 v[24:27], v1 offset:49152
    s_waitcnt vmcnt(14)
    v_mfma_f32_32x32x16_bf16 v[80:95], v[28:31], a[52:55], v[80:95]
    buffer_load_dwordx4 a[92:95], v1, s[20:23], s36 offen offset:3072 sc1
    ds_read_b128 v[28:31], v13 offset:17408
    s_waitcnt lgkmcnt(8)
    v_mfma_f32_32x32x16_bf16 v[96:111], v[32:35], a[52:55], v[96:111]
    ds_read_b128 v[32:35], v1 offset:17408
    v_mfma_f32_32x32x16_bf16 v[112:127], v[36:39], a[52:55], v[112:127]
    ds_read_b128 v[36:39], v1 offset:50176
    s_waitcnt vmcnt(13)
    v_mfma_f32_32x32x16_bf16 v[80:95], v[40:43], a[56:59], v[80:95]
    s_mov_b32 s36, 24576
    buffer_load_dwordx4 a[96:99], v1, s[20:23], s36 offen offset:0 sc1
    ds_read_b128 v[40:43], v13 offset:18432
    v_mfma_f32_32x32x16_bf16 v[96:111], v[44:47], a[56:59], v[96:111]
    ds_read_b128 v[44:47], v1 offset:18432
    s_waitcnt lgkmcnt(8)
    v_mfma_f32_32x32x16_bf16 v[112:127], v[48:51], a[56:59], v[112:127]
    ds_read_b128 v[48:51], v1 offset:51200
    s_waitcnt vmcnt(12)
    v_mfma_f32_32x32x16_bf16 v[80:95], v[52:55], a[60:63], v[80:95]
    buffer_load_dwordx4 a[100:103], v1, s[20:23], s36 offen offset:1024 sc1
    ds_read_b128 v[52:55], v13 offset:19456
    v_mfma_f32_32x32x16_bf16 v[96:111], v[56:59], a[60:63], v[96:111]
    s_waitcnt vmcnt(8)
    v_add_f32 v192, v192, v200
    v_add_f32 v193, v193, v201
    ds_read_b128 v[56:59], v1 offset:19456
    v_mfma_f32_32x32x16_bf16 v[112:127], v[60:63], a[60:63], v[112:127]
    v_add_f32 v194, v194, v202
    v_add_f32 v195, v195, v203
    v_add_f32 v196, v196, v204
    ds_read_b128 v[60:63], v1 offset:52224
    s_waitcnt lgkmcnt(8)
    s_waitcnt vmcnt(11)
    v_mfma_f32_32x32x16_bf16 v[80:95], v[16:19], a[64:67], v[80:95]
    v_add_f32 v197, v197, v205
    ds_read_b128 v[16:19], v13 offset:20480
    v_mfma_f32_32x32x16_bf16 v[96:111], v[20:23], a[64:67], v[96:111]
    buffer_load_dwordx4 a[104:107], v1, s[20:23], s36 offen offset:2048 sc1
    ds_read_b128 v[20:23], v1 offset:20480
    v_mfma_f32_32x32x16_bf16 v[112:127], v[24:27], a[64:67], v[112:127]
    v_add_f32 v198, v198, v206
    v_add_f32 v199, v199, v207
    v_add_f32 v192, v192, v196
    ds_read_b128 v[24:27], v1 offset:53248
    s_waitcnt vmcnt(10)
    v_mfma_f32_32x32x16_bf16 v[80:95], v[28:31], a[68:71], v[80:95]
    buffer_load_dwordx4 a[108:111], v1, s[20:23], s36 offen offset:3072 sc1
    ds_read_b128 v[28:31], v13 offset:21504
    s_waitcnt lgkmcnt(8)
    v_mfma_f32_32x32x16_bf16 v[96:111], v[32:35], a[68:71], v[96:111]
    v_add_f32 v193, v193, v197
    v_add_f32 v194, v194, v198
    ds_read_b128 v[32:35], v1 offset:21504
    v_mfma_f32_32x32x16_bf16 v[112:127], v[36:39], a[68:71], v[112:127]
    v_add_f32 v195, v195, v199
    v_add_f32 v192, v192, v194
    v_add_f32 v193, v193, v195
    ds_read_b128 v[36:39], v1 offset:54272
    s_waitcnt vmcnt(9)
    v_mfma_f32_32x32x16_bf16 v[80:95], v[40:43], a[72:75], v[80:95]
    s_mov_b32 s36, 28672
    buffer_load_dwordx4 a[112:115], v1, s[20:23], s36 offen offset:0 sc1
    ds_read_b128 v[40:43], v13 offset:22528
    v_mfma_f32_32x32x16_bf16 v[96:111], v[44:47], a[72:75], v[96:111]
    v_mov_b32 v194, v192
    v_mov_b32 v195, v193
    s_nop 1
    ds_read_b128 v[44:47], v1 offset:22528
    s_waitcnt lgkmcnt(8)
    v_mfma_f32_32x32x16_bf16 v[112:127], v[48:51], a[72:75], v[112:127]
    v_permlane32_swap_b32 v192, v194
    v_permlane32_swap_b32 v193, v195
    ds_read_b128 v[48:51], v1 offset:55296
    s_waitcnt vmcnt(9)
    v_mfma_f32_32x32x16_bf16 v[80:95], v[52:55], a[76:79], v[80:95]
    buffer_load_dwordx4 a[116:119], v1, s[20:23], s36 offen offset:1024 sc1
    ds_read_b128 v[52:55], v13 offset:23552
    v_mfma_f32_32x32x16_bf16 v[96:111], v[56:59], a[76:79], v[96:111]
    s_nop 0
    v_add_f32 v192, v192, v194
    v_add_f32 v193, v193, v195
    ds_read_b128 v[56:59], v1 offset:23552
    v_mfma_f32_32x32x16_bf16 v[112:127], v[60:63], a[76:79], v[112:127]
    v_mul_f32 v192, 0x3b000000, v192
    v_mul_f32 v193, 0x3b000000, v193
    v_fma_f32 v193, -v192, v192, v193
    ds_read_b128 v[60:63], v1 offset:56320
    s_waitcnt lgkmcnt(8)
    s_waitcnt vmcnt(9)
    v_mfma_f32_32x32x16_bf16 v[80:95], v[16:19], a[80:83], v[80:95]
    v_add_f32 v4, 0x3727c5ac, v193
    ds_read_b128 v[16:19], v13 offset:24576
    v_mfma_f32_32x32x16_bf16 v[96:111], v[20:23], a[80:83], v[96:111]
    buffer_load_dwordx4 a[120:123], v1, s[20:23], s36 offen offset:2048 sc1
    ds_read_b128 v[20:23], v1 offset:24576
    v_mfma_f32_32x32x16_bf16 v[112:127], v[24:27], a[80:83], v[112:127]
    v_rsq_f32 v5, v4
    v_sub_f32 v194, 0, v192
    v_mul_f32 v5, 0xbfb8aa3b, v5
    ds_read_b128 v[24:27], v1 offset:57344
    s_waitcnt vmcnt(9)
    v_mfma_f32_32x32x16_bf16 v[80:95], v[28:31], a[84:87], v[80:95]
    buffer_load_dwordx4 a[124:127], v1, s[20:23], s36 offen offset:3072 sc1
    ds_read_b128 v[28:31], v13 offset:25600
    s_waitcnt lgkmcnt(8)
    v_mfma_f32_32x32x16_bf16 v[96:111], v[32:35], a[84:87], v[96:111]
    v_cvt_pk_bf16_f32 v195, v194, v194
    v_and_b32 v196, 0xffff0000, v195
    ds_read_b128 v[32:35], v1 offset:25600
    v_mfma_f32_32x32x16_bf16 v[112:127], v[36:39], a[84:87], v[112:127]
    v_sub_f32 v196, v194, v196
    v_cvt_pk_bf16_f32 v196, v196, v196
    v_and_b32 v196, 0xffff, v196
    ds_read_b128 v[36:39], v1 offset:58368
    s_waitcnt vmcnt(9)
    v_mfma_f32_32x32x16_bf16 v[80:95], v[40:43], a[88:91], v[80:95]
    s_add_u32 m0, s83, 98304
    s_add_u32 s35, s83, 131072
    buffer_load_dwordx4 v1, s[84:87], s35 offen offset:0 lds
    ds_read_b128 v[40:43], v13 offset:26624
    v_mfma_f32_32x32x16_bf16 v[96:111], v[44:47], a[88:91], v[96:111]
    v_cmp_gt_u32 vcc, 32, v0
    v_mov_b32 v78, 0
    v_mov_b32 v79, 0
    ds_read_b128 v[44:47], v1 offset:26624
    s_waitcnt lgkmcnt(8)
    v_mfma_f32_32x32x16_bf16 v[112:127], v[48:51], a[88:91], v[112:127]
    v_cndmask_b32 v76, 0, v195, vcc
    v_cndmask_b32 v77, 0, v196, vcc
    ds_read_b128 v[48:51], v1 offset:59392
    s_waitcnt vmcnt(9)
    v_mfma_f32_32x32x16_bf16 v[80:95], v[52:55], a[92:95], v[80:95]
    buffer_load_dwordx4 v1, s[84:87], s35 offen offset:1024 lds
    ds_read_b128 v[52:55], v13 offset:27648
    v_mfma_f32_32x32x16_bf16 v[96:111], v[56:59], a[92:95], v[96:111]
    ds_read_b128 v[56:59], v1 offset:27648
    v_mfma_f32_32x32x16_bf16 v[112:127], v[60:63], a[92:95], v[112:127]
    ds_read_b128 v[60:63], v1 offset:60416
    s_waitcnt lgkmcnt(8)
    s_waitcnt vmcnt(9)
    v_mfma_f32_32x32x16_bf16 v[80:95], v[16:19], a[96:99], v[80:95]
    ds_read_b128 v[16:19], v13 offset:28672
    v_mfma_f32_32x32x16_bf16 v[96:111], v[20:23], a[96:99], v[96:111]
    buffer_load_dwordx4 v1, s[84:87], s35 offen offset:2048 lds
    ds_read_b128 v[20:23], v1 offset:28672
    v_mfma_f32_32x32x16_bf16 v[112:127], v[24:27], a[96:99], v[112:127]
    ds_read_b128 v[24:27], v1 offset:61440
    s_waitcnt vmcnt(9)
    v_mfma_f32_32x32x16_bf16 v[80:95], v[28:31], a[100:103], v[80:95]
    buffer_load_dwordx4 v1, s[84:87], s35 offen offset:3072 lds
    ds_read_b128 v[28:31], v13 offset:29696
    s_waitcnt lgkmcnt(8)
    v_mfma_f32_32x32x16_bf16 v[96:111], v[32:35], a[100:103], v[96:111]
    ds_read_b128 v[32:35], v1 offset:29696
    v_mfma_f32_32x32x16_bf16 v[112:127], v[36:39], a[100:103], v[112:127]
    ds_read_b128 v[36:39], v1 offset:62464
    s_waitcnt vmcnt(9)
    v_mfma_f32_32x32x16_bf16 v[80:95], v[40:43], a[104:107], v[80:95]
    s_add_u32 m0, s83, 102400
    s_add_u32 s35, s83, 135168
    buffer_load_dwordx4 v1, s[84:87], s35 offen offset:0 lds
    ds_read_b128 v[40:43], v13 offset:30720
    v_mfma_f32_32x32x16_bf16 v[96:111], v[44:47], a[104:107], v[96:111]
    ds_read_b128 v[44:47], v1 offset:30720
    s_waitcnt lgkmcnt(8)
    v_mfma_f32_32x32x16_bf16 v[112:127], v[48:51], a[104:107], v[112:127]
    ds_read_b128 v[48:51], v1 offset:63488
    s_waitcnt vmcnt(9)
    v_mfma_f32_32x32x16_bf16 v[80:95], v[52:55], a[108:111], v[80:95]
    buffer_load_dwordx4 v1, s[84:87], s35 offen offset:1024 lds
    ds_read_b128 v[52:55], v13 offset:31744
    v_mfma_f32_32x32x16_bf16 v[96:111], v[56:59], a[108:111], v[96:111]
    ds_read_b128 v[56:59], v1 offset:31744
    v_mfma_f32_32x32x16_bf16 v[112:127], v[60:63], a[108:111], v[112:127]
    ds_read_b128 v[60:63], v1 offset:64512
    s_waitcnt lgkmcnt(8)
    s_waitcnt vmcnt(9)
    v_mfma_f32_32x32x16_bf16 v[80:95], v[16:19], a[112:115], v[80:95]
    ds_read_b128 v[16:19], v3 offset:0
    v_mfma_f32_32x32x16_bf16 v[96:111], v[20:23], a[112:115], v[96:111]
    buffer_load_dwordx4 v1, s[84:87], s35 offen offset:2048 lds
    ds_read_b128 v[20:23], v3 offset:1024
    v_mfma_f32_32x32x16_bf16 v[112:127], v[24:27], a[112:115], v[112:127]
    ds_read_b128 v[24:27], v3 offset:2048
    s_waitcnt vmcnt(9)
    v_mfma_f32_32x32x16_bf16 v[80:95], v[28:31], a[116:119], v[80:95]
    buffer_load_dwordx4 v1, s[84:87], s35 offen offset:3072 lds
    ds_read_b128 v[28:31], v3 offset:3072
    s_waitcnt lgkmcnt(8)
    v_mfma_f32_32x32x16_bf16 v[96:111], v[32:35], a[116:119], v[96:111]
    ds_read_b128 v[32:35], v3 offset:4096
    v_mfma_f32_32x32x16_bf16 v[112:127], v[36:39], a[116:119], v[112:127]
    ds_read_b128 v[36:39], v3 offset:5120
    s_waitcnt vmcnt(9)
    v_mfma_f32_32x32x16_bf16 v[80:95], v[40:43], a[120:123], v[80:95]
    ds_read_b128 v[40:43], v3 offset:6144
    v_mfma_f32_32x32x16_bf16 v[96:111], v[44:47], a[120:123], v[96:111]
    ds_read_b128 v[44:47], v3 offset:7168
    s_waitcnt lgkmcnt(8)
    v_mfma_f32_32x32x16_bf16 v[112:127], v[48:51], a[120:123], v[112:127]
    ds_read_b128 v[48:51], v3 offset:8192
    s_waitcnt vmcnt(8)
    v_mfma_f32_32x32x16_bf16 v[80:95], v[52:55], a[124:127], v[80:95]
    v_mfma_f32_32x32x16_bf16 v[80:95], v[226:229], v[76:79], v[80:95]
    ds_read_b128 v[52:55], v3 offset:9216
    v_mfma_f32_32x32x16_bf16 v[96:111], v[56:59], a[124:127], v[96:111]
    v_mfma_f32_32x32x16_bf16 v[96:111], v[230:233], v[76:79], v[96:111]
    ds_read_b128 v[56:59], v3 offset:10240
    v_mfma_f32_32x32x16_bf16 v[112:127], v[60:63], a[124:127], v[112:127]
    v_mfma_f32_32x32x16_bf16 v[112:127], v[234:237], v[76:79], v[112:127]
    ds_read_b128 v[60:63], v3 offset:11264
    s_waitcnt lgkmcnt(8)
    v_mfma_f32_32x32x16_bf16 v[128:143], v[16:19], a[0:3], 0
    s_barrier
    ds_read_b128 v[16:19], v3 offset:12288
    v_mfma_f32_32x32x16_bf16 v[128:143], v[20:23], a[4:7], v[128:143]
    v_mul_f32 v192, v5, v80
    v_mul_f32 v193, v5, v81
    v_mul_f32 v194, v5, v82
    v_mul_f32 v195, v5, v83
    ds_read_b128 v[20:23], v3 offset:13312
    v_mfma_f32_32x32x16_bf16 v[128:143], v[24:27], a[8:11], v[128:143]
    s_add_u32 m0, s83, 131072
    s_add_u32 s35, s83, 163840
    buffer_load_dwordx4 v1, s[84:87], s35 offen offset:0 lds
    v_mul_f32 v196, v5, v84
    ds_read_b128 v[24:27], v3 offset:14336
    v_mfma_f32_32x32x16_bf16 v[128:143], v[28:31], a[12:15], v[128:143]
    v_mul_f32 v197, v5, v85
    v_mul_f32 v198, v5, v86
    v_mul_f32 v199, v5, v87
    ds_read_b128 v[28:31], v3 offset:15360
    s_waitcnt lgkmcnt(8)
    v_mfma_f32_32x32x16_bf16 v[128:143], v[32:35], a[16:19], v[128:143]
    s_add_u32 s76, s0, 0
    buffer_load_dwordx4 a[128:131], v1, s[92:95], s76 offen
    ds_read_b128 v[32:35], v3 offset:16384
    v_mfma_f32_32x32x16_bf16 v[128:143], v[36:39], a[20:23], v[128:143]
    buffer_load_dwordx4 v1, s[84:87], s35 offen offset:1024 lds
    ds_read_b128 v[36:39], v3 offset:17408
    v_mfma_f32_32x32x16_bf16 v[128:143], v[40:43], a[24:27], v[128:143]
    buffer_load_dwordx4 v1, s[84:87], s35 offen offset:2048 lds
    ds_read_b128 v[40:43], v3 offset:18432
    v_mfma_f32_32x32x16_bf16 v[128:143], v[44:47], a[28:31], v[128:143]
    v_exp_f32 v192, v192
    v_exp_f32 v193, v193
    ds_read_b128 v[44:47], v3 offset:19456
    s_waitcnt lgkmcnt(8)
    v_mfma_f32_32x32x16_bf16 v[128:143], v[48:51], a[32:35], v[128:143]
    buffer_load_dwordx4 v1, s[84:87], s35 offen offset:3072 lds
    ds_read_b128 v[48:51], v3 offset:20480
    v_mfma_f32_32x32x16_bf16 v[128:143], v[52:55], a[36:39], v[128:143]
    s_add_u32 s76, s1, 0
    buffer_load_dwordx4 a[132:135], v1, s[92:95], s76 offen
    ds_read_b128 v[52:55], v3 offset:21504
    v_mfma_f32_32x32x16_bf16 v[128:143], v[56:59], a[40:43], v[128:143]
    s_add_u32 m0, s83, 135168
    s_add_u32 s35, s83, 167936
    buffer_load_dwordx4 v1, s[84:87], s35 offen offset:0 lds
    ds_read_b128 v[56:59], v3 offset:22528
    v_mfma_f32_32x32x16_bf16 v[128:143], v[60:63], a[44:47], v[128:143]
    v_exp_f32 v194, v194
    v_exp_f32 v195, v195
    ds_read_b128 v[60:63], v3 offset:23552
    s_waitcnt lgkmcnt(8)
    v_mfma_f32_32x32x16_bf16 v[128:143], v[16:19], a[48:51], v[128:143]
    s_add_u32 s76, s3, 0
    buffer_load_dwordx4 a[136:139], v1, s[92:95], s76 offen
    ds_read_b128 v[16:19], v3 offset:24576
    v_mfma_f32_32x32x16_bf16 v[128:143], v[20:23], a[52:55], v[128:143]
    buffer_load_dwordx4 v1, s[84:87], s35 offen offset:1024 lds
    ds_read_b128 v[20:23], v3 offset:25600
    v_mfma_f32_32x32x16_bf16 v[128:143], v[24:27], a[56:59], v[128:143]
    buffer_load_dwordx4 v1, s[84:87], s35 offen offset:2048 lds
    ds_read_b128 v[24:27], v3 offset:26624
    v_mfma_f32_32x32x16_bf16 v[128:143], v[28:31], a[60:63], v[128:143]
    v_exp_f32 v196, v196
    v_exp_f32 v197, v197
    ds_read_b128 v[28:31], v3 offset:27648
    s_waitcnt lgkmcnt(8)
    v_mfma_f32_32x32x16_bf16 v[128:143], v[32:35], a[64:67], v[128:143]
    buffer_load_dwordx4 v1, s[84:87], s35 offen offset:3072 lds
    ds_read_b128 v[32:35], v3 offset:28672
    v_mfma_f32_32x32x16_bf16 v[128:143], v[36:39], a[68:71], v[128:143]
    s_add_u32 s76, s77, 0
    buffer_load_dwordx4 a[140:143], v1, s[92:95], s76 offen
    ds_read_b128 v[36:39], v3 offset:29696
    v_mfma_f32_32x32x16_bf16 v[128:143], v[40:43], a[72:75], v[128:143]
    s_add_u32 m0, s83, 0
    s_add_u32 s35, s83, 196608
    buffer_load_dwordx4 v1, s[84:87], s35 offen offset:0 lds
    ds_read_b128 v[40:43], v3 offset:30720
    v_mfma_f32_32x32x16_bf16 v[128:143], v[44:47], a[76:79], v[128:143]
    v_exp_f32 v198, v198
    v_exp_f32 v199, v199
    ds_read_b128 v[44:47], v3 offset:31744
    s_waitcnt lgkmcnt(8)
    v_mfma_f32_32x32x16_bf16 v[128:143], v[48:51], a[80:83], v[128:143]
    s_add_u32 s76, s81, 0
    buffer_load_dwordx4 a[144:147], v1, s[92:95], s76 offen
    s_waitcnt vmcnt(14)
    s_barrier
    ds_read_b128 v[48:51], v3 offset:32768
    v_mfma_f32_32x32x16_bf16 v[128:143], v[52:55], a[84:87], v[128:143]
    buffer_load_dwordx4 v1, s[84:87], s35 offen offset:1024 lds
    v_mul_f32 v200, v80, v88
    ds_read_b128 v[52:55], v3 offset:33792
    v_mfma_f32_32x32x16_bf16 v[128:143], v[56:59], a[88:91], v[128:143]
    buffer_load_dwordx4 v1, s[84:87], s35 offen offset:2048 lds
    v_mul_f32 v201, v81, v89
    ds_read_b128 v[56:59], v3 offset:34816
    v_mfma_f32_32x32x16_bf16 v[128:143], v[60:63], a[92:95], v[128:143]
    v_mul_f32 v202, v82, v90
    v_mul_f32 v203, v83, v91
    v_mul_f32 v204, v84, v92
    v_mul_f32 v205, v85, v93
    ds_read_b128 v[60:63], v3 offset:35840
    s_waitcnt lgkmcnt(8)
    v_mfma_f32_32x32x16_bf16 v[128:143], v[16:19], a[96:99], v[128:143]
    buffer_load_dwordx4 v1, s[84:87], s35 offen offset:3072 lds
    ds_read_b128 v[16:19], v3 offset:36864
    v_mfma_f32_32x32x16_bf16 v[128:143], v[20:23], a[100:103], v[128:143]
    s_add_u32 s76, s98, 0
    buffer_load_dwordx4 a[148:151], v1, s[92:95], s76 offen
    v_mul_f32 v206, v86, v94
    ds_read_b128 v[20:23], v3 offset:37888
    v_mfma_f32_32x32x16_bf16 v[128:143], v[24:27], a[104:107], v[128:143]
    s_add_u32 m0, s83, 4096
    s_add_u32 s35, s83, 200704
    buffer_load_dwordx4 v1, s[84:87], s35 offen offset:0 lds
    v_mul_f32 v207, v87, v95
    ds_read_b128 v[24:27], v3 offset:38912
    v_mfma_f32_32x32x16_bf16 v[128:143], v[28:31], a[108:111], v[128:143]
    v_fma_f32 v192, v192, v4, v4
    v_fma_f32 v193, v193, v4, v4
    v_fma_f32 v194, v194, v4, v4
    v_fma_f32 v195, v195, v4, v4
    ds_read_b128 v[28:31], v3 offset:39936
    s_waitcnt lgkmcnt(8)
    v_mfma_f32_32x32x16_bf16 v[128:143], v[32:35], a[112:115], v[128:143]
    s_add_u32 s76, s99, 0
    buffer_load_dwordx4 a[152:155], v1, s[92:95], s76 offen
    ds_read_b128 v[32:35], v3 offset:40960
    v_mfma_f32_32x32x16_bf16 v[128:143], v[36:39], a[116:119], v[128:143]
    buffer_load_dwordx4 v1, s[84:87], s35 offen offset:1024 lds
    v_fma_f32 v196, v196, v4, v4
    ds_read_b128 v[36:39], v3 offset:41984
    v_mfma_f32_32x32x16_bf16 v[128:143], v[40:43], a[120:123], v[128:143]
    buffer_load_dwordx4 v1, s[84:87], s35 offen offset:2048 lds
    v_fma_f32 v197, v197, v4, v4
    ds_read_b128 v[40:43], v3 offset:43008
    v_mfma_f32_32x32x16_bf16 v[128:143], v[44:47], a[124:127], v[128:143]
    v_mfma_f32_32x32x16_bf16 v[128:143], v[238:241], v[76:79], v[128:143]
    v_fma_f32 v198, v198, v4, v4
    v_fma_f32 v199, v199, v4, v4
    v_rcp_f32 v192, v192
    v_rcp_f32 v193, v193
    v_rcp_f32 v194, v194
    ds_read_b128 v[44:47], v3 offset:44032
    s_waitcnt lgkmcnt(8)
    v_mfma_f32_32x32x16_bf16 v[144:159], v[48:51], a[0:3], 0
    buffer_load_dwordx4 v1, s[84:87], s35 offen offset:3072 lds
    ds_read_b128 v[48:51], v3 offset:45056
    v_mfma_f32_32x32x16_bf16 v[144:159], v[52:55], a[4:7], v[144:159]
    s_add_u32 s76, s0, 7168
    buffer_load_dwordx4 a[156:159], v1, s[92:95], s76 offen
    ds_read_b128 v[52:55], v3 offset:46080
    v_mfma_f32_32x32x16_bf16 v[144:159], v[56:59], a[8:11], v[144:159]
    v_rcp_f32 v195, v195
    v_rcp_f32 v196, v196
    ds_read_b128 v[56:59], v3 offset:47104
    v_mfma_f32_32x32x16_bf16 v[144:159], v[60:63], a[12:15], v[144:159]
    v_rcp_f32 v197, v197
    v_rcp_f32 v198, v198
    ds_read_b128 v[60:63], v3 offset:48128
    s_waitcnt lgkmcnt(8)
    v_mfma_f32_32x32x16_bf16 v[144:159], v[16:19], a[16:19], v[144:159]
    s_add_u32 s76, s1, 7168
    buffer_load_dwordx4 a[160:163], v1, s[92:95], s76 offen
    ds_read_b128 v[16:19], v3 offset:49152
    v_mfma_f32_32x32x16_bf16 v[144:159], v[20:23], a[20:23], v[144:159]
    v_rcp_f32 v199, v199
    v_mul_f32 v200, v200, v192
    v_mul_f32 v201, v201, v193
    ds_read_b128 v[20:23], v3 offset:50176
    v_mfma_f32_32x32x16_bf16 v[144:159], v[24:27], a[24:27], v[144:159]
    v_mul_f32 v202, v202, v194
    v_mul_f32 v203, v203, v195
    v_mul_f32 v204, v204, v196
    v_mul_f32 v205, v205, v197
    ds_read_b128 v[24:27], v3 offset:51200
    v_mfma_f32_32x32x16_bf16 v[144:159], v[28:31], a[28:31], v[144:159]
    v_mul_f32 v206, v206, v198
    v_mul_f32 v207, v207, v199
    s_branch warm_over_1
warm_stub_1:
    s_branch warm_ret
warm_over_1:
    v_cvt_pk_bf16_f32 v208, v200, v201
    v_cvt_pk_bf16_f32 v209, v202, v203
    ds_read_b128 v[28:31], v3 offset:52224
    s_waitcnt lgkmcnt(8)
    v_mfma_f32_32x32x16_bf16 v[144:159], v[32:35], a[32:35], v[144:159]
    v_cvt_pk_bf16_f32 v210, v204, v205
    v_cvt_pk_bf16_f32 v211, v206, v207
    ds_read_b128 v[32:35], v3 offset:53248
    v_mfma_f32_32x32x16_bf16 v[144:159], v[36:39], a[36:39], v[144:159]
    s_add_u32 s76, s3, 7168
    buffer_load_dwordx4 a[164:167], v1, s[92:95], s76 offen
    ds_read_b128 v[36:39], v3 offset:54272
    v_mfma_f32_32x32x16_bf16 v[144:159], v[40:43], a[40:43], v[144:159]
    s_nop 1
    v_permlane32_swap_b32 v208, v210
    v_permlane32_swap_b32 v209, v211
    ds_read_b128 v[40:43], v3 offset:55296
    v_mfma_f32_32x32x16_bf16 v[144:159], v[44:47], a[44:47], v[144:159]
    buffer_store_dwordx4 v[208:211], v1, s[48:51], 0 offen offset:0 sc1
    v_mul_f32 v192, v5, v96
    v_mul_f32 v193, v5, v97
    v_mul_f32 v194, v5, v98
    ds_read_b128 v[44:47], v3 offset:56320
    s_waitcnt lgkmcnt(8)
    v_mfma_f32_32x32x16_bf16 v[144:159], v[48:51], a[48:51], v[144:159]
    s_add_u32 s76, s77, 7168
    buffer_load_dwordx4 a[168:171], v1, s[92:95], s76 offen
    ds_read_b128 v[48:51], v3 offset:57344
    v_mfma_f32_32x32x16_bf16 v[144:159], v[52:55], a[52:55], v[144:159]
    v_mul_f32 v195, v5, v99
    v_mul_f32 v196, v5, v100
    v_mul_f32 v197, v5, v101
    v_mul_f32 v198, v5, v102
    ds_read_b128 v[52:55], v3 offset:58368
    v_mfma_f32_32x32x16_bf16 v[144:159], v[56:59], a[56:59], v[144:159]
    v_mul_f32 v199, v5, v103
    v_exp_f32 v192, v192
    ds_read_b128 v[56:59], v3 offset:59392
    v_mfma_f32_32x32x16_bf16 v[144:159], v[60:63], a[60:63], v[144:159]
    v_exp_f32 v193, v193
    v_exp_f32 v194, v194
    ds_read_b128 v[60:63], v3 offset:60416
    s_waitcnt lgkmcnt(8)
    v_mfma_f32_32x32x16_bf16 v[144:159], v[16:19], a[64:67], v[144:159]
    v_exp_f32 v195, v195
    ds_read_b128 v[16:19], v3 offset:61440
    v_mfma_f32_32x32x16_bf16 v[144:159], v[20:23], a[68:71], v[144:159]
    s_add_u32 s76, s81, 7168
    buffer_load_dwordx4 a[172:175], v1, s[92:95], s76 offen
    ds_read_b128 v[20:23], v3 offset:62464
    v_mfma_f32_32x32x16_bf16 v[144:159], v[24:27], a[72:75], v[144:159]
    v_exp_f32 v196, v196
    v_exp_f32 v197, v197
    ds_read_b128 v[24:27], v3 offset:63488
    v_mfma_f32_32x32x16_bf16 v[144:159], v[28:31], a[76:79], v[144:159]
    v_exp_f32 v198, v198
    v_exp_f32 v199, v199
    ds_read_b128 v[28:31], v3 offset:64512
    s_waitcnt lgkmcnt(8)
    v_mfma_f32_32x32x16_bf16 v[144:159], v[32:35], a[80:83], v[144:159]
    s_add_u32 s76, s98, 7168
    buffer_load_dwordx4 a[176:179], v1, s[92:95], s76 offen
    s_waitcnt vmcnt(19)
    s_barrier
    ds_read_b128 v[32:35], v13 offset:0
    v_mfma_f32_32x32x16_bf16 v[144:159], v[36:39], a[84:87], v[144:159]
    v_mul_f32 v200, v96, v104
    v_mul_f32 v201, v97, v105
    v_mul_f32 v202, v98, v106
    v_mul_f32 v203, v99, v107
    ds_read_b128 v[36:39], v13 offset:1024
    v_mfma_f32_32x32x16_bf16 v[144:159], v[40:43], a[88:91], v[144:159]
    v_mul_f32 v204, v100, v108
    v_mul_f32 v205, v101, v109
    v_mul_f32 v206, v102, v110
    v_mul_f32 v207, v103, v111
    ds_read_b128 v[40:43], v13 offset:2048
    v_mfma_f32_32x32x16_bf16 v[144:159], v[44:47], a[92:95], v[144:159]
    v_fma_f32 v192, v192, v4, v4
    v_fma_f32 v193, v193, v4, v4
    v_fma_f32 v194, v194, v4, v4
    v_fma_f32 v195, v195, v4, v4
    ds_read_b128 v[44:47], v13 offset:3072
    s_waitcnt lgkmcnt(8)
    v_mfma_f32_32x32x16_bf16 v[144:159], v[48:51], a[96:99], v[144:159]
    v_fma_f32 v196, v196, v4, v4
    v_fma_f32 v197, v197, v4, v4
    v_fma_f32 v198, v198, v4, v4
    ds_read_b128 v[48:51], v13 offset:4096
    v_mfma_f32_32x32x16_bf16 v[144:159], v[52:55], a[100:103], v[144:159]
    s_add_u32 s76, s99, 7168
    buffer_load_dwordx4 a[180:183], v1, s[92:95], s76 offen
    v_fma_f32 v199, v199, v4, v4
    ds_read_b128 v[52:55], v13 offset:5120
    v_mfma_f32_32x32x16_bf16 v[144:159], v[56:59], a[104:107], v[144:159]
    v_rcp_f32 v192, v192
    v_rcp_f32 v193, v193
    ds_read_b128 v[56:59], v13 offset:6144
    v_mfma_f32_32x32x16_bf16 v[144:159], v[60:63], a[108:111], v[144:159]
    v_rcp_f32 v194, v194
    v_rcp_f32 v195, v195
    ds_read_b128 v[60:63], v13 offset:7168
    s_waitcnt lgkmcnt(8)
    v_mfma_f32_32x32x16_bf16 v[144:159], v[16:19], a[112:115], v[144:159]
    s_add_u32 s76, s0, 14336
    buffer_load_dwordx4 a[184:187], v1, s[92:95], s76 offen
    ds_read_b128 v[16:19], v13 offset:8192
    v_mfma_f32_32x32x16_bf16 v[144:159], v[20:23], a[116:119], v[144:159]
    v_rcp_f32 v196, v196
    v_rcp_f32 v197, v197
    ds_read_b128 v[20:23], v13 offset:9216
    v_mfma_f32_32x32x16_bf16 v[144:159], v[24:27], a[120:123], v[144:159]
    v_rcp_f32 v198, v198
    v_rcp_f32 v199, v199
    ds_read_b128 v[24:27], v13 offset:10240
    v_mfma_f32_32x32x16_bf16 v[144:159], v[28:31], a[124:127], v[144:159]
    v_mfma_f32_32x32x16_bf16 v[144:159], v[242:245], v[76:79], v[144:159]
    v_mul_f32 v200, v200, v192
    v_mul_f32 v201, v201, v193
    v_mul_f32 v202, v202, v194
    v_mul_f32 v203, v203, v195
    v_mul_f32 v204, v204, v196
    v_mul_f32 v205, v205, v197
    v_mul_f32 v206, v206, v198
    v_mul_f32 v207, v207, v199
    v_cvt_pk_bf16_f32 v208, v200, v201
    ds_read_b128 v[28:31], v13 offset:11264
    s_waitcnt lgkmcnt(8)
    v_mfma_f32_32x32x16_bf16 v[160:175], v[32:35], a[0:3], 0
    v_cvt_pk_bf16_f32 v209, v202, v203
    v_cvt_pk_bf16_f32 v210, v204, v205
    v_cvt_pk_bf16_f32 v211, v206, v207
    ds_read_b128 v[32:35], v13 offset:12288
    v_mfma_f32_32x32x16_bf16 v[160:175], v[36:39], a[4:7], v[160:175]
    s_add_u32 s76, s1, 14336
    buffer_load_dwordx4 a[188:191], v1, s[92:95], s76 offen
    ds_read_b128 v[36:39], v13 offset:13312
    v_mfma_f32_32x32x16_bf16 v[160:175], v[40:43], a[8:11], v[160:175]
    s_nop 1
    v_permlane32_swap_b32 v208, v210
    v_permlane32_swap_b32 v209, v211
    ds_read_b128 v[40:43], v13 offset:14336
    v_mfma_f32_32x32x16_bf16 v[160:175], v[44:47], a[12:15], v[160:175]
    buffer_store_dwordx4 v[208:211], v1, s[48:51], 0 offen offset:1024 sc1
    v_mul_f32 v192, v5, v112
    v_mul_f32 v193, v5, v113
    v_mul_f32 v194, v5, v114
    ds_read_b128 v[44:47], v13 offset:15360
    s_waitcnt lgkmcnt(8)
    v_mfma_f32_32x32x16_bf16 v[160:175], v[48:51], a[16:19], v[160:175]
    s_add_u32 s76, s3, 14336
    buffer_load_dwordx4 a[192:195], v1, s[92:95], s76 offen
    ds_read_b128 v[48:51], v13 offset:16384
    v_mfma_f32_32x32x16_bf16 v[160:175], v[52:55], a[20:23], v[160:175]
    v_mul_f32 v195, v5, v115
    v_mul_f32 v196, v5, v116
    v_mul_f32 v197, v5, v117
    v_mul_f32 v198, v5, v118
    ds_read_b128 v[52:55], v13 offset:17408
    v_mfma_f32_32x32x16_bf16 v[160:175], v[56:59], a[24:27], v[160:175]
    v_mul_f32 v199, v5, v119
    v_exp_f32 v192, v192
    ds_read_b128 v[56:59], v13 offset:18432
    v_mfma_f32_32x32x16_bf16 v[160:175], v[60:63], a[28:31], v[160:175]
    v_exp_f32 v193, v193
    v_exp_f32 v194, v194
    ds_read_b128 v[60:63], v13 offset:19456
    s_waitcnt lgkmcnt(8)
    v_mfma_f32_32x32x16_bf16 v[160:175], v[16:19], a[32:35], v[160:175]
    v_exp_f32 v195, v195
    ds_read_b128 v[16:19], v13 offset:20480
    v_mfma_f32_32x32x16_bf16 v[160:175], v[20:23], a[36:39], v[160:175]
    s_add_u32 s76, s77, 14336
    buffer_load_dwordx4 a[196:199], v1, s[92:95], s76 offen
    ds_read_b128 v[20:23], v13 offset:21504
    v_mfma_f32_32x32x16_bf16 v[160:175], v[24:27], a[40:43], v[160:175]
    v_exp_f32 v196, v196
    v_exp_f32 v197, v197
    ds_read_b128 v[24:27], v13 offset:22528
    v_mfma_f32_32x32x16_bf16 v[160:175], v[28:31], a[44:47], v[160:175]
    v_exp_f32 v198, v198
    v_exp_f32 v199, v199
    ds_read_b128 v[28:31], v13 offset:23552
    s_waitcnt lgkmcnt(8)
    v_mfma_f32_32x32x16_bf16 v[160:175], v[32:35], a[48:51], v[160:175]
    s_add_u32 s76, s81, 14336
    buffer_load_dwordx4 a[200:203], v1, s[92:95], s76 offen
    ds_read_b128 v[32:35], v13 offset:24576
    v_mfma_f32_32x32x16_bf16 v[160:175], v[36:39], a[52:55], v[160:175]
    v_mul_f32 v200, v112, v120
    v_mul_f32 v201, v113, v121
    v_mul_f32 v202, v114, v122
    v_mul_f32 v203, v115, v123
    ds_read_b128 v[36:39], v13 offset:25600
    v_mfma_f32_32x32x16_bf16 v[160:175], v[40:43], a[56:59], v[160:175]
    v_mul_f32 v204, v116, v124
    v_mul_f32 v205, v117, v125
    v_mul_f32 v206, v118, v126
    v_mul_f32 v207, v119, v127
    ds_read_b128 v[40:43], v13 offset:26624
    v_mfma_f32_32x32x16_bf16 v[160:175], v[44:47], a[60:63], v[160:175]
    v_fma_f32 v192, v192, v4, v4
    v_fma_f32 v193, v193, v4, v4
    v_fma_f32 v194, v194, v4, v4
    v_fma_f32 v195, v195, v4, v4
    ds_read_b128 v[44:47], v13 offset:27648
    s_waitcnt lgkmcnt(8)
    v_mfma_f32_32x32x16_bf16 v[160:175], v[48:51], a[64:67], v[160:175]
    v_fma_f32 v196, v196, v4, v4
    v_fma_f32 v197, v197, v4, v4
    v_fma_f32 v198, v198, v4, v4
    ds_read_b128 v[48:51], v13 offset:28672
    v_mfma_f32_32x32x16_bf16 v[160:175], v[52:55], a[68:71], v[160:175]
    s_add_u32 s76, s98, 14336
    buffer_load_dwordx4 a[204:207], v1, s[92:95], s76 offen
    v_fma_f32 v199, v199, v4, v4
    ds_read_b128 v[52:55], v13 offset:29696
    v_mfma_f32_32x32x16_bf16 v[160:175], v[56:59], a[72:75], v[160:175]
    v_rcp_f32 v192, v192
    v_rcp_f32 v193, v193
    ds_read_b128 v[56:59], v13 offset:30720
    v_mfma_f32_32x32x16_bf16 v[160:175], v[60:63], a[76:79], v[160:175]
    v_rcp_f32 v194, v194
    v_rcp_f32 v195, v195
    ds_read_b128 v[60:63], v13 offset:31744
    s_waitcnt lgkmcnt(8)
    v_mfma_f32_32x32x16_bf16 v[160:175], v[16:19], a[80:83], v[160:175]
    s_add_u32 s76, s99, 14336
    buffer_load_dwordx4 a[208:211], v1, s[92:95], s76 offen
    s_waitcnt vmcnt(16)
    s_barrier
    ds_read_b128 v[16:19], v1 offset:0
    v_mfma_f32_32x32x16_bf16 v[160:175], v[20:23], a[84:87], v[160:175]
    v_rcp_f32 v196, v196
    v_rcp_f32 v197, v197
    ds_read_b128 v[20:23], v1 offset:1024
    v_mfma_f32_32x32x16_bf16 v[160:175], v[24:27], a[88:91], v[160:175]
    v_rcp_f32 v198, v198
    v_rcp_f32 v199, v199
    ds_read_b128 v[24:27], v1 offset:2048
    v_mfma_f32_32x32x16_bf16 v[160:175], v[28:31], a[92:95], v[160:175]
    v_mul_f32 v200, v200, v192
    v_mul_f32 v201, v201, v193
    v_mul_f32 v202, v202, v194
    v_mul_f32 v203, v203, v195
    ds_read_b128 v[28:31], v1 offset:3072
    s_waitcnt lgkmcnt(8)
    v_mfma_f32_32x32x16_bf16 v[160:175], v[32:35], a[96:99], v[160:175]
    v_mul_f32 v204, v204, v196
    v_mul_f32 v205, v205, v197
    v_mul_f32 v206, v206, v198
    ds_read_b128 v[32:35], v1 offset:4096
    v_mfma_f32_32x32x16_bf16 v[160:175], v[36:39], a[100:103], v[160:175]
    s_add_u32 s76, s0, 21504
    buffer_load_dwordx4 a[212:215], v1, s[92:95], s76 offen
    v_mul_f32 v207, v207, v199
    ds_read_b128 v[36:39], v1 offset:5120
    v_mfma_f32_32x32x16_bf16 v[160:175], v[40:43], a[104:107], v[160:175]
    v_cvt_pk_bf16_f32 v208, v200, v201
    v_cvt_pk_bf16_f32 v209, v202, v203
    v_cvt_pk_bf16_f32 v210, v204, v205
    v_cvt_pk_bf16_f32 v211, v206, v207
    ds_read_b128 v[40:43], v1 offset:6144
    v_mfma_f32_32x32x16_bf16 v[160:175], v[44:47], a[108:111], v[160:175]
    s_nop 1
    v_permlane32_swap_b32 v208, v210
    v_permlane32_swap_b32 v209, v211
    ds_read_b128 v[44:47], v1 offset:7168
    s_waitcnt lgkmcnt(8)
    v_mfma_f32_32x32x16_bf16 v[160:175], v[48:51], a[112:115], v[160:175]
    s_add_u32 s76, s1, 21504
    buffer_load_dwordx4 a[216:219], v1, s[92:95], s76 offen
    ds_read_b128 v[48:51], v1 offset:8192
    v_mfma_f32_32x32x16_bf16 v[160:175], v[52:55], a[116:119], v[160:175]
    buffer_store_dwordx4 v[208:211], v1, s[48:51], 0 offen offset:2048 sc1
    v_mul_f32 v192, v5, v128
    v_mul_f32 v193, v5, v129
    v_mul_f32 v194, v5, v130
    ds_read_b128 v[52:55], v1 offset:9216
    v_mfma_f32_32x32x16_bf16 v[160:175], v[56:59], a[120:123], v[160:175]
    v_mul_f32 v195, v5, v131
    v_mul_f32 v196, v5, v132
    v_mul_f32 v197, v5, v133
    ds_read_b128 v[56:59], v1 offset:10240
    v_mfma_f32_32x32x16_bf16 v[160:175], v[60:63], a[124:127], v[160:175]
    v_mfma_f32_32x32x16_bf16 v[160:175], v[246:249], v[76:79], v[160:175]
    v_mul_f32 v198, v5, v134
    v_mul_f32 v199, v5, v135
    v_exp_f32 v192, v192
    v_exp_f32 v193, v193
    v_exp_f32 v194, v194
    ds_read_b128 v[60:63], v1 offset:11264
    s_waitcnt lgkmcnt(8)
    v_mfma_f32_32x32x16_bf16 v[176:191], v[16:19], a[0:3], 0
    v_exp_f32 v195, v195
    ds_read_b128 v[16:19], v1 offset:12288
    v_mfma_f32_32x32x16_bf16 v[176:191], v[20:23], a[4:7], v[176:191]
    s_add_u32 s76, s3, 21504
    buffer_load_dwordx4 a[220:223], v1, s[92:95], s76 offen
    ds_read_b128 v[20:23], v1 offset:13312
    v_mfma_f32_32x32x16_bf16 v[176:191], v[24:27], a[8:11], v[176:191]
    v_exp_f32 v196, v196
    ds_read_b128 v[24:27], v1 offset:14336
    v_mfma_f32_32x32x16_bf16 v[176:191], v[28:31], a[12:15], v[176:191]
    v_exp_f32 v197, v197
    ds_read_b128 v[28:31], v1 offset:15360
    s_waitcnt lgkmcnt(8)
    v_mfma_f32_32x32x16_bf16 v[176:191], v[32:35], a[16:19], v[176:191]
    s_add_u32 s76, s77, 21504
    buffer_load_dwordx4 a[224:227], v1, s[92:95], s76 offen
    ds_read_b128 v[32:35], v1 offset:16384
    v_mfma_f32_32x32x16_bf16 v[176:191], v[36:39], a[20:23], v[176:191]
    v_exp_f32 v198, v198
    ds_read_b128 v[36:39], v1 offset:17408
    v_mfma_f32_32x32x16_bf16 v[176:191], v[40:43], a[24:27], v[176:191]
    v_exp_f32 v199, v199
    v_mul_f32 v200, v128, v136
    ds_read_b128 v[40:43], v1 offset:18432
    v_mfma_f32_32x32x16_bf16 v[176:191], v[44:47], a[28:31], v[176:191]
    v_mul_f32 v201, v129, v137
    v_mul_f32 v202, v130, v138
    v_mul_f32 v203, v131, v139
    ds_read_b128 v[44:47], v1 offset:19456
    s_waitcnt lgkmcnt(8)
    v_mfma_f32_32x32x16_bf16 v[176:191], v[48:51], a[32:35], v[176:191]
    v_mul_f32 v204, v132, v140
    v_mul_f32 v205, v133, v141
    ds_read_b128 v[48:51], v1 offset:20480
    v_mfma_f32_32x32x16_bf16 v[176:191], v[52:55], a[36:39], v[176:191]
    s_add_u32 s76, s81, 21504
    buffer_load_dwordx4 a[228:231], v1, s[92:95], s76 offen
    ds_read_b128 v[52:55], v1 offset:21504
    v_mfma_f32_32x32x16_bf16 v[176:191], v[56:59], a[40:43], v[176:191]
    v_mul_f32 v206, v134, v142
    v_mul_f32 v207, v135, v143
    v_fma_f32 v192, v192, v4, v4
    ds_read_b128 v[56:59], v1 offset:22528
    v_mfma_f32_32x32x16_bf16 v[176:191], v[60:63], a[44:47], v[176:191]
    v_fma_f32 v193, v193, v4, v4
    v_fma_f32 v194, v194, v4, v4
    v_fma_f32 v195, v195, v4, v4
    ds_read_b128 v[60:63], v1 offset:23552
    s_waitcnt lgkmcnt(8)
    v_mfma_f32_32x32x16_bf16 v[176:191], v[16:19], a[48:51], v[176:191]
    s_add_u32 s76, s98, 21504
    buffer_load_dwordx4 a[232:235], v1, s[92:95], s76 offen
    ds_read_b128 v[16:19], v1 offset:24576
    v_mfma_f32_32x32x16_bf16 v[176:191], v[20:23], a[52:55], v[176:191]
    v_fma_f32 v196, v196, v4, v4
    v_fma_f32 v197, v197, v4, v4
    v_fma_f32 v198, v198, v4, v4
    ds_read_b128 v[20:23], v1 offset:25600
    v_mfma_f32_32x32x16_bf16 v[176:191], v[24:27], a[56:59], v[176:191]
    v_fma_f32 v199, v199, v4, v4
    v_rcp_f32 v192, v192
    ds_read_b128 v[24:27], v1 offset:26624
    v_mfma_f32_32x32x16_bf16 v[176:191], v[28:31], a[60:63], v[176:191]
    v_rcp_f32 v193, v193
    ds_read_b128 v[28:31], v1 offset:27648
    s_waitcnt lgkmcnt(8)
    v_mfma_f32_32x32x16_bf16 v[176:191], v[32:35], a[64:67], v[176:191]
    v_rcp_f32 v194, v194
    ds_read_b128 v[32:35], v1 offset:28672
    v_mfma_f32_32x32x16_bf16 v[176:191], v[36:39], a[68:71], v[176:191]
    s_add_u32 s76, s99, 21504
    buffer_load_dwordx4 a[236:239], v1, s[92:95], s76 offen
    ds_read_b128 v[36:39], v1 offset:29696
    v_mfma_f32_32x32x16_bf16 v[176:191], v[40:43], a[72:75], v[176:191]
    v_rcp_f32 v195, v195
    ds_read_b128 v[40:43], v1 offset:30720
    v_mfma_f32_32x32x16_bf16 v[176:191], v[44:47], a[76:79], v[176:191]
    s_waitcnt vmcnt(5)
    s_barrier
    s_cmp_lg_u32 s10, 0
    s_cbranch_scc1 esig_40
    s_mov_b64 exec, 1
    global_atomic_add v9, v12, s[4:5] sc1
    s_mov_b64 exec, -1
esig_40:
    ds_read_b128 v[44:47], v1 offset:31744
    s_waitcnt lgkmcnt(8)
    v_mfma_f32_32x32x16_bf16 v[176:191], v[48:51], a[80:83], v[176:191]
    v_rcp_f32 v196, v196
    v_mfma_f32_32x32x16_bf16 v[176:191], v[52:55], a[84:87], v[176:191]
    v_rcp_f32 v197, v197
    v_mfma_f32_32x32x16_bf16 v[176:191], v[56:59], a[88:91], v[176:191]
    v_rcp_f32 v198, v198
    v_mfma_f32_32x32x16_bf16 v[176:191], v[60:63], a[92:95], v[176:191]
    v_rcp_f32 v199, v199
    v_mul_f32 v200, v200, v192
    s_waitcnt lgkmcnt(4)
    v_mfma_f32_32x32x16_bf16 v[176:191], v[16:19], a[96:99], v[176:191]
    v_mul_f32 v201, v201, v193
    v_mul_f32 v202, v202, v194
    v_mfma_f32_32x32x16_bf16 v[176:191], v[20:23], a[100:103], v[176:191]
    v_mul_f32 v203, v203, v195
    v_mul_f32 v204, v204, v196
    v_mul_f32 v205, v205, v197
    v_mfma_f32_32x32x16_bf16 v[176:191], v[24:27], a[104:107], v[176:191]
    v_mul_f32 v206, v206, v198
    v_mul_f32 v207, v207, v199
    v_cvt_pk_bf16_f32 v208, v200, v201
    v_mfma_f32_32x32x16_bf16 v[176:191], v[28:31], a[108:111], v[176:191]
    v_cvt_pk_bf16_f32 v209, v202, v203
    v_cvt_pk_bf16_f32 v210, v204, v205
    v_cvt_pk_bf16_f32 v211, v206, v207
    s_waitcnt lgkmcnt(0)
    v_mfma_f32_32x32x16_bf16 v[176:191], v[32:35], a[112:115], v[176:191]
    s_nop 1
    v_mfma_f32_32x32x16_bf16 v[176:191], v[36:39], a[116:119], v[176:191]
    v_permlane32_swap_b32 v208, v210
    v_permlane32_swap_b32 v209, v211
    buffer_store_dwordx4 v[208:211], v1, s[48:51], 0 offen offset:3072 sc1
    v_mfma_f32_32x32x16_bf16 v[176:191], v[40:43], a[120:123], v[176:191]
    v_mul_f32 v192, v5, v144
    v_mul_f32 v193, v5, v145
    v_mul_f32 v194, v5, v146
    v_mfma_f32_32x32x16_bf16 v[176:191], v[44:47], a[124:127], v[176:191]
    v_mfma_f32_32x32x16_bf16 v[176:191], v[250:253], v[76:79], v[176:191]
    v_mul_f32 v195, v5, v147
    v_mul_f32 v196, v5, v148
    v_mul_f32 v197, v5, v149
    v_mul_f32 v198, v5, v150
    v_mul_f32 v199, v5, v151
    v_exp_f32 v192, v192
    s_add_u32 s76, s0, 114688
    buffer_load_dwordx4 a[0:3], v1, s[92:95], s76 offen
    s_add_u32 s76, s0, 121856
    buffer_load_dwordx4 a[28:31], v1, s[92:95], s76 offen
    s_add_u32 s76, s0, 129024
    buffer_load_dwordx4 a[56:59], v1, s[92:95], s76 offen
    s_add_u32 s76, s0, 136192
    buffer_load_dwordx4 a[84:87], v1, s[92:95], s76 offen
    s_add_u32 s76, s1, 114688
    buffer_load_dwordx4 a[4:7], v1, s[92:95], s76 offen
    s_add_u32 s76, s1, 121856
    buffer_load_dwordx4 a[32:35], v1, s[92:95], s76 offen
    s_add_u32 s76, s1, 129024
    buffer_load_dwordx4 a[60:63], v1, s[92:95], s76 offen
    s_add_u32 s76, s1, 136192
    buffer_load_dwordx4 a[88:91], v1, s[92:95], s76 offen
    s_add_u32 s76, s3, 114688
    buffer_load_dwordx4 a[8:11], v1, s[92:95], s76 offen
    s_add_u32 s76, s3, 121856
    buffer_load_dwordx4 a[36:39], v1, s[92:95], s76 offen
    v_exp_f32 v193, v193
    v_exp_f32 v194, v194
    v_exp_f32 v195, v195
    v_exp_f32 v196, v196
    v_exp_f32 v197, v197
    v_exp_f32 v198, v198
    v_exp_f32 v199, v199
    v_mul_f32 v200, v144, v152
    v_mul_f32 v201, v145, v153
    v_mul_f32 v202, v146, v154
    v_mul_f32 v203, v147, v155
    v_mul_f32 v204, v148, v156
    v_mul_f32 v205, v149, v157
    v_mul_f32 v206, v150, v158
    v_mul_f32 v207, v151, v159
    v_fma_f32 v192, v192, v4, v4
    v_fma_f32 v193, v193, v4, v4
    v_fma_f32 v194, v194, v4, v4
    v_fma_f32 v195, v195, v4, v4
    v_fma_f32 v196, v196, v4, v4
    v_fma_f32 v197, v197, v4, v4
    v_fma_f32 v198, v198, v4, v4
    v_fma_f32 v199, v199, v4, v4
    v_rcp_f32 v192, v192
    v_rcp_f32 v193, v193
    v_rcp_f32 v194, v194
    v_rcp_f32 v195, v195
    v_rcp_f32 v196, v196
    v_rcp_f32 v197, v197
    v_rcp_f32 v198, v198
    v_rcp_f32 v199, v199
    v_mul_f32 v200, v200, v192
    v_mul_f32 v201, v201, v193
    v_mul_f32 v202, v202, v194
    v_mul_f32 v203, v203, v195
    v_mul_f32 v204, v204, v196
    v_mul_f32 v205, v205, v197
    v_mul_f32 v206, v206, v198
    v_mul_f32 v207, v207, v199
    v_cvt_pk_bf16_f32 v208, v200, v201
    v_cvt_pk_bf16_f32 v209, v202, v203
    v_cvt_pk_bf16_f32 v210, v204, v205
    v_cvt_pk_bf16_f32 v211, v206, v207
    s_nop 1
    v_permlane32_swap_b32 v208, v210
    v_permlane32_swap_b32 v209, v211
    buffer_store_dwordx4 v[208:211], v1, s[48:51], s38 offen offset:0 sc1
    s_nop 11
    v_mov_b32 v212, v5
    v_mov_b32 v213, v5
    v_mov_b32 v214, v4
    v_mov_b32 v215, v4
    v_pk_mul_f32 v[192:193], v[160:161], v[212:213]
    v_pk_mul_f32 v[194:195], v[162:163], v[212:213]
    v_pk_mul_f32 v[196:197], v[164:165], v[212:213]
    v_pk_mul_f32 v[198:199], v[166:167], v[212:213]
    v_exp_f32 v192, v192
    v_exp_f32 v193, v193
    v_exp_f32 v194, v194
    v_exp_f32 v195, v195
    v_exp_f32 v196, v196
    v_exp_f32 v197, v197
    v_exp_f32 v198, v198
    v_exp_f32 v199, v199
    v_pk_mul_f32 v[200:201], v[160:161], v[168:169]
    v_pk_mul_f32 v[202:203], v[162:163], v[170:171]
    v_pk_mul_f32 v[204:205], v[164:165], v[172:173]
    v_pk_mul_f32 v[206:207], v[166:167], v[174:175]
    v_pk_fma_f32 v[192:193], v[192:193], v[214:215], v[214:215]
    v_pk_fma_f32 v[194:195], v[194:195], v[214:215], v[214:215]
    v_pk_fma_f32 v[196:197], v[196:197], v[214:215], v[214:215]
    v_pk_fma_f32 v[198:199], v[198:199], v[214:215], v[214:215]
    v_rcp_f32 v192, v192
    v_rcp_f32 v193, v193
    v_rcp_f32 v194, v194
    v_rcp_f32 v195, v195
    v_rcp_f32 v196, v196
    v_rcp_f32 v197, v197
    v_rcp_f32 v198, v198
    v_rcp_f32 v199, v199
    s_nop 0
    v_pk_mul_f32 v[200:201], v[200:201], v[192:193]
    v_pk_mul_f32 v[202:203], v[202:203], v[194:195]
    v_pk_mul_f32 v[204:205], v[204:205], v[196:197]
    v_pk_mul_f32 v[206:207], v[206:207], v[198:199]
    v_cvt_pk_bf16_f32 v208, v200, v201
    v_cvt_pk_bf16_f32 v209, v202, v203
    v_cvt_pk_bf16_f32 v210, v204, v205
    v_cvt_pk_bf16_f32 v211, v206, v207
    s_nop 1
    v_permlane32_swap_b32 v208, v210
    v_permlane32_swap_b32 v209, v211
    buffer_store_dwordx4 v[208:211], v1, s[48:51], s38 offen offset:1024 sc1
    v_mov_b32 v212, v5
    v_mov_b32 v213, v5
    v_mov_b32 v214, v4
    v_mov_b32 v215, v4
    v_pk_mul_f32 v[192:193], v[176:177], v[212:213]
    v_pk_mul_f32 v[194:195], v[178:179], v[212:213]
    v_pk_mul_f32 v[196:197], v[180:181], v[212:213]
    v_pk_mul_f32 v[198:199], v[182:183], v[212:213]
    v_exp_f32 v192, v192
    v_exp_f32 v193, v193
    v_exp_f32 v194, v194
    v_exp_f32 v195, v195
    v_exp_f32 v196, v196
    v_exp_f32 v197, v197
    v_exp_f32 v198, v198
    v_exp_f32 v199, v199
    v_pk_mul_f32 v[200:201], v[176:177], v[184:185]
    v_pk_mul_f32 v[202:203], v[178:179], v[186:187]
    v_pk_mul_f32 v[204:205], v[180:181], v[188:189]
    v_pk_mul_f32 v[206:207], v[182:183], v[190:191]
    v_pk_fma_f32 v[192:193], v[192:193], v[214:215], v[214:215]
    v_pk_fma_f32 v[194:195], v[194:195], v[214:215], v[214:215]
    v_pk_fma_f32 v[196:197], v[196:197], v[214:215], v[214:215]
    v_pk_fma_f32 v[198:199], v[198:199], v[214:215], v[214:215]
    v_rcp_f32 v192, v192
    v_rcp_f32 v193, v193
    v_rcp_f32 v194, v194
    v_rcp_f32 v195, v195
    v_rcp_f32 v196, v196
    v_rcp_f32 v197, v197
    v_rcp_f32 v198, v198
    v_rcp_f32 v199, v199
    s_nop 0
    v_pk_mul_f32 v[200:201], v[200:201], v[192:193]
    v_pk_mul_f32 v[202:203], v[202:203], v[194:195]
    v_pk_mul_f32 v[204:205], v[204:205], v[196:197]
    v_pk_mul_f32 v[206:207], v[206:207], v[198:199]
    v_cvt_pk_bf16_f32 v208, v200, v201
    v_cvt_pk_bf16_f32 v209, v202, v203
    v_cvt_pk_bf16_f32 v210, v204, v205
    v_cvt_pk_bf16_f32 v211, v206, v207
    s_nop 1
    v_permlane32_swap_b32 v208, v210
    v_permlane32_swap_b32 v209, v211
    buffer_store_dwordx4 v[208:211], v1, s[48:51], s38 offen offset:2048 sc1
    s_lshl_b32 s54, s11, 1
    s_lshr_b32 s55, s12, 4
    s_add_u32 s54, s54, s55
    s_lshl_b32 s54, s54, 7
    s_add_u32 s55, s54, s46
    v_mov_b32 v214, s55
    s_add_u32 s55, s54, s45
    v_mov_b32 v215, s55
    global_load_dword v216, v214, s[4:5] sc1
    s_lshl_b32 s54, s89, 7
    s_add_u32 s54, s54, s45
    v_mov_b32 v217, s54
    s_mul_i32 s40, s72, 0x700000
    s_add_u32 s40, s40, 0x1600000
    s_mul_i32 s41, s72, 0x1
    s_add_u32 s41, s41, 0x0
    s_mul_i32 s42, s72, 0x400000
    s_add_u32 s42, s42, 0x0
    s_mov_b32 s43, 0x200000
    s_mov_b32 s44, 0x2700000
    s_mov_b32 s46, 0x2506000
    s_and_b32 s13, s12, 7
    s_lshr_b32 s14, s12, 3
    s_and_b32 s50, s10, 1
    s_lshr_b32 s51, s10, 1
    s_lshl_b32 s36, s13, 1
    s_add_u32 s52, s36, s50
    s_lshl_b32 s37, s11, 3
    s_lshl_b32 s38, s14, 1
    s_add_u32 s37, s37, s38
    s_lshl_b32 s56, s52, 1
    s_add_u32 s56, s56, s51
    v_and_b32 v4, 31, v0
    v_lshrrev_b32 v6, 4, v4
    v_lshlrev_b32 v6, 2, v6
    v_and_b32 v5, 3, v4
    v_add_u32 v5, v5, v6
    v_lshlrev_b32 v5, 8, v5
    v_bfe_u32 v6, v4, 2, 2
    v_lshl_add_u32 v5, v6, 3, v5
    v_lshrrev_b32 v7, 5, v0
    s_add_u32 s20, s4, s42
    s_addc_u32 s21, s5, 0
    s_mov_b32 s22, 0x200000
    s_mov_b32 s23, 0x20000
    s_mov_b32 s57, 0
    s_add_u32 s53, s37, s57
    s_mul_i32 s58, s57, 114688
    s_lshl_b32 s54, s53, 15
    s_lshl_b32 s55, s56, 10
    s_add_u32 s54, s54, s55
    v_add_u32 v14, s54, v1
    buffer_load_dwordx4 v[192:195], v14, s[20:23], 0 offen sc1
    s_and_b32 s55, s53, 7
    s_lshl_b32 s55, s55, 5
    s_add_u32 s55, s55, s11
    v_add_u32 v15, s55, v5
    v_lshlrev_b32 v15, 10, v15
    v_lshl_add_u32 v15, v7, 4, v15
    s_lshl_b32 s55, s56, 5
    v_add_u32 v15, s55, v15
    s_cmp_eq_u32 s41, 0
    s_cselect_b64 vcc, -1, 0
    v_cndmask_b32 v8, v15, v14, vcc
    s_lshl_b32 s54, s53, 13
    s_lshl_b32 s55, s56, 8
    s_add_u32 s54, s54, s55
    v_lshlrev_b32 v10, 3, v4
    v_add_u32 v10, s54, v10
    s_mov_b32 s57, 0
    s_xor_b32 s57, s57, 1
    s_add_u32 s53, s37, s57
    s_mul_i32 s59, s57, 114688
    s_lshl_b32 s54, s53, 15
    s_lshl_b32 s55, s56, 10
    s_add_u32 s54, s54, s55
    v_add_u32 v14, s54, v1
    buffer_load_dwordx4 v[196:199], v14, s[20:23], 0 offen sc1
    s_and_b32 s55, s53, 7
    s_lshl_b32 s55, s55, 5
    s_add_u32 s55, s55, s11
    v_add_u32 v15, s55, v5
    v_lshlrev_b32 v15, 10, v15
    v_lshl_add_u32 v15, v7, 4, v15
    s_lshl_b32 s55, s56, 5
    v_add_u32 v15, s55, v15
    s_cmp_eq_u32 s41, 0
    s_cselect_b64 vcc, -1, 0
    v_cndmask_b32 v9, v15, v14, vcc
    s_lshl_b32 s54, s53, 13
    s_lshl_b32 s55, s56, 8
    s_add_u32 s54, s54, s55
    v_lshlrev_b32 v11, 3, v4
    v_add_u32 v11, s54, v11
    s_add_u32 s24, s4, s43
    s_addc_u32 s25, s5, 0
    s_cmp_eq_u32 s41, 0
    s_branch warm_over_2
warm_stub_2:
warm_chain_2:
    s_branch warm_stub_3
warm_over_2:
    s_cselect_b32 s24, s24, s8
    s_cselect_b32 s25, s25, s9
    s_mov_b32 s26, 0x200000
    s_mov_b32 s27, 0x20000
    s_add_u32 s28, s4, s44
    s_addc_u32 s29, s5, 0
    s_mov_b32 s30, 0x80000
    s_mov_b32 s31, 0x20000
    s_lshl_b32 s54, s10, 14
    v_add_u32 v12, s54, v1
    s_lshl_b32 s54, s10, 11
    v_add_u32 v13, s54, v1
    s_mul_i32 s54, s37, 114688
    s_add_u32 s54, s54, s40
    s_add_u32 s20, s4, s54
    s_addc_u32 s21, s5, 0
    s_mov_b32 s22, 0x38000
    s_mov_b32 s23, 0x20000
    s_and_b32 s13, s12, 7
    s_lshr_b32 s14, s12, 3
    s_and_b32 s50, s10, 1
    s_lshr_b32 s51, s10, 1
    v_lshrrev_b32 v202, 3, v0
    v_and_b32 v203, 7, v0
    s_lshl_b32 s54, s13, 5
    s_lshl_b32 s55, s50, 4
    s_add_u32 s54, s54, s55
    s_add_u32 s54, s54, 1
    s_cmp_eq_u32 s51, 0
    s_cselect_b32 s16, s60, s62
    s_cselect_b32 s17, s61, s63
    s_mov_b32 s18, 0x80000
    s_mov_b32 s19, 0x20000
    v_add_u32 v204, 0, v202
    v_lshrrev_b32 v205, 1, v204
    v_xor_b32 v205, v205, v203
    v_lshlrev_b32 v205, 4, v205
    v_add_u32 v204, s54, v204
    v_lshl_add_u32 v200, v204, 10, v205
    v_add_u32 v204, 8, v202
    v_lshrrev_b32 v205, 1, v204
    v_xor_b32 v205, v205, v203
    v_lshlrev_b32 v205, 4, v205
    v_add_u32 v204, s54, v204
    v_lshl_add_u32 v201, v204, 10, v205
    s_lshl_b32 s33, s50, 12
    s_lshl_b32 s55, s51, 11
    s_add_u32 s33, s33, s55
    s_cmp_eq_u32 s72, 0
    s_cselect_b32 s18, s18, 0
    s_waitcnt vmcnt(2)
    v_cmp_gt_u32 vcc, 16, v216
    s_cbranch_vccz wcd_42
    s_cmp_lg_u32 s73, 0
    s_cbranch_scc1 wcd_42
    s_mov_b32 s74, 0
wc_41:
    global_load_dword v216, v214, s[4:5] sc1
    s_add_u32 s74, s74, 1
    s_waitcnt vmcnt(0)
    v_cmp_gt_u32 vcc, 16, v216
    s_cbranch_vccz wcd_42
    s_cmp_lt_u32 s74, 40000
    s_cbranch_scc1 wc_41
    s_mov_b32 s73, 1
wcd_42:
    s_add_u32 s91, s0, s58
    buffer_load_dwordx4 v[80:83], v1, s[20:23], s91 offen sc1
    s_add_u32 s91, s0, s58
    s_add_u32 s91, s91, 7168
    buffer_load_dwordx4 v[84:87], v1, s[20:23], s91 offen sc1
    s_add_u32 s91, s0, s58
    s_add_u32 s91, s91, 14336
    buffer_load_dwordx4 v[88:91], v1, s[20:23], s91 offen sc1
    s_add_u32 s91, s0, s58
    s_add_u32 s91, s91, 21504
    buffer_load_dwordx4 v[92:95], v1, s[20:23], s91 offen sc1
    s_waitcnt vmcnt(6)
    s_barrier
    s_cmp_lg_u32 s10, 0
    s_cbranch_scc1 sig_43
    s_mov_b64 exec, 1
    v_mov_b32 v2, 1
    global_atomic_add v217, v2, s[4:5] sc1
    s_mov_b64 exec, -1
sig_43:
    s_add_u32 s91, s1, s58
    buffer_load_dwordx4 v[96:99], v1, s[20:23], s91 offen sc1
    s_add_u32 s91, s1, s58
    s_add_u32 s91, s91, 7168
    buffer_load_dwordx4 v[100:103], v1, s[20:23], s91 offen sc1
    s_add_u32 s91, s1, s58
    s_add_u32 s91, s91, 14336
    buffer_load_dwordx4 v[104:107], v1, s[20:23], s91 offen sc1
    s_add_u32 s91, s1, s58
    s_add_u32 s91, s91, 21504
    buffer_load_dwordx4 v[108:111], v1, s[20:23], s91 offen sc1
    s_add_u32 s91, s3, s58
    buffer_load_dwordx4 v[112:115], v1, s[20:23], s91 offen sc1
    s_add_u32 s91, s3, s58
    s_add_u32 s91, s91, 7168
    buffer_load_dwordx4 v[116:119], v1, s[20:23], s91 offen sc1
    s_add_u32 s76, s3, 129024
    buffer_load_dwordx4 a[64:67], v1, s[92:95], s76 offen
    s_add_u32 s91, s3, s58
    s_add_u32 s91, s91, 14336
    buffer_load_dwordx4 v[120:123], v1, s[20:23], s91 offen sc1
    s_add_u32 s76, s3, 136192
    buffer_load_dwordx4 a[92:95], v1, s[92:95], s76 offen
    s_add_u32 s91, s3, s58
    s_add_u32 s91, s91, 21504
    buffer_load_dwordx4 v[124:127], v1, s[20:23], s91 offen sc1
    s_add_u32 s91, s0, s59
    buffer_load_dwordx4 v[128:131], v1, s[20:23], s91 offen sc1
    s_add_u32 s91, s0, s59
    s_add_u32 s91, s91, 7168
    buffer_load_dwordx4 v[132:135], v1, s[20:23], s91 offen sc1
    v_add_u32 v220, 0x10000, v12
    v_add_u32 v222, 0x10000, v13
    v_add_u32 v221, 0x0, v12
    v_add_u32 v223, 0x0, v13
    s_waitcnt vmcnt(15)
    s_add_u32 s91, s0, s59
    s_add_u32 s91, s91, 14336
    buffer_load_dwordx4 v[136:139], v1, s[20:23], s91 offen sc1
    v_mfma_f32_32x32x16_bf16 v[16:31], a[128:131], v[80:83], 0
    v_mfma_f32_32x32x16_bf16 v[32:47], a[0:3], v[80:83], 0
    s_waitcnt vmcnt(15)
    s_add_u32 s91, s0, s59
    s_add_u32 s91, s91, 21504
    buffer_load_dwordx4 v[140:143], v1, s[20:23], s91 offen sc1
    v_mfma_f32_32x32x16_bf16 v[16:31], a[156:159], v[84:87], v[16:31]
    v_mfma_f32_32x32x16_bf16 v[32:47], a[28:31], v[84:87], v[32:47]
    s_waitcnt vmcnt(15)
    s_add_u32 s91, s1, s59
    buffer_load_dwordx4 v[144:147], v1, s[20:23], s91 offen sc1
    v_mfma_f32_32x32x16_bf16 v[16:31], a[184:187], v[88:91], v[16:31]
    v_mfma_f32_32x32x16_bf16 v[32:47], a[56:59], v[88:91], v[32:47]
    s_waitcnt vmcnt(15)
    s_add_u32 s91, s1, s59
    s_add_u32 s91, s91, 7168
    buffer_load_dwordx4 v[148:151], v1, s[20:23], s91 offen sc1
    v_mfma_f32_32x32x16_bf16 v[16:31], a[212:215], v[92:95], v[16:31]
    v_mfma_f32_32x32x16_bf16 v[32:47], a[84:87], v[92:95], v[32:47]
    s_waitcnt vmcnt(15)
    s_add_u32 s91, s1, s59
    s_add_u32 s91, s91, 14336
    buffer_load_dwordx4 v[152:155], v1, s[20:23], s91 offen sc1
    v_mfma_f32_32x32x16_bf16 v[16:31], a[132:135], v[96:99], v[16:31]
    v_mfma_f32_32x32x16_bf16 v[32:47], a[4:7], v[96:99], v[32:47]
    s_waitcnt vmcnt(15)
    s_add_u32 s91, s1, s59
    s_add_u32 s91, s91, 21504
    buffer_load_dwordx4 v[156:159], v1, s[20:23], s91 offen sc1
    v_mfma_f32_32x32x16_bf16 v[16:31], a[160:163], v[100:103], v[16:31]
    v_mfma_f32_32x32x16_bf16 v[32:47], a[32:35], v[100:103], v[32:47]
    s_waitcnt vmcnt(15)
    s_add_u32 s91, s3, s59
    buffer_load_dwordx4 v[160:163], v1, s[20:23], s91 offen sc1
    v_mfma_f32_32x32x16_bf16 v[16:31], a[188:191], v[104:107], v[16:31]
    v_mfma_f32_32x32x16_bf16 v[32:47], a[60:63], v[104:107], v[32:47]
    s_waitcnt vmcnt(15)
    s_add_u32 s91, s3, s59
    s_add_u32 s91, s91, 7168
    buffer_load_dwordx4 v[164:167], v1, s[20:23], s91 offen sc1
    v_mfma_f32_32x32x16_bf16 v[16:31], a[216:219], v[108:111], v[16:31]
    v_mfma_f32_32x32x16_bf16 v[32:47], a[88:91], v[108:111], v[32:47]
    s_waitcnt vmcnt(15)
    s_add_u32 s91, s3, s59
    s_add_u32 s91, s91, 14336
    buffer_load_dwordx4 v[168:171], v1, s[20:23], s91 offen sc1
    v_mfma_f32_32x32x16_bf16 v[16:31], a[136:139], v[112:115], v[16:31]
    v_mfma_f32_32x32x16_bf16 v[32:47], a[8:11], v[112:115], v[32:47]
    s_waitcnt vmcnt(15)
    s_add_u32 s91, s3, s59
    s_add_u32 s91, s91, 21504
    buffer_load_dwordx4 v[172:175], v1, s[20:23], s91 offen sc1
    v_mfma_f32_32x32x16_bf16 v[16:31], a[164:167], v[116:119], v[16:31]
    v_mfma_f32_32x32x16_bf16 v[32:47], a[36:39], v[116:119], v[32:47]
    global_load_dword v216, v215, s[4:5] sc1
    s_waitcnt vmcnt(15)
    v_mfma_f32_32x32x16_bf16 v[16:31], a[192:195], v[120:123], v[16:31]
    v_mfma_f32_32x32x16_bf16 v[32:47], a[64:67], v[120:123], v[32:47]
    s_waitcnt vmcnt(13)
    v_mfma_f32_32x32x16_bf16 v[16:31], a[220:223], v[124:127], v[16:31]
    v_mfma_f32_32x32x16_bf16 v[32:47], a[92:95], v[124:127], v[32:47]
    s_waitcnt vmcnt(12)
    v_mfma_f32_32x32x16_bf16 v[48:63], a[128:131], v[128:131], 0
    v_mfma_f32_32x32x16_bf16 v[64:79], a[0:3], v[128:131], 0
    s_waitcnt vmcnt(11)
    v_mfma_f32_32x32x16_bf16 v[48:63], a[156:159], v[132:135], v[48:63]
    v_mfma_f32_32x32x16_bf16 v[64:79], a[28:31], v[132:135], v[64:79]
    s_waitcnt vmcnt(10)
    v_mfma_f32_32x32x16_bf16 v[48:63], a[184:187], v[136:139], v[48:63]
    v_mfma_f32_32x32x16_bf16 v[64:79], a[56:59], v[136:139], v[64:79]
    s_waitcnt vmcnt(9)
    v_mfma_f32_32x32x16_bf16 v[48:63], a[212:215], v[140:143], v[48:63]
    v_mfma_f32_32x32x16_bf16 v[64:79], a[84:87], v[140:143], v[64:79]
    s_waitcnt vmcnt(8)
    v_mfma_f32_32x32x16_bf16 v[48:63], a[132:135], v[144:147], v[48:63]
    v_mfma_f32_32x32x16_bf16 v[64:79], a[4:7], v[144:147], v[64:79]
    s_waitcnt vmcnt(0)
    v_cmp_gt_u32 vcc, 16, v216
    s_cbranch_vccz wcd_45
    s_cmp_lg_u32 s73, 0
    s_cbranch_scc1 wcd_45
    s_mov_b32 s74, 0
wc_44:
    global_load_dword v216, v215, s[4:5] sc1
    s_add_u32 s74, s74, 1
    s_waitcnt vmcnt(0)
    v_cmp_gt_u32 vcc, 16, v216
    s_cbranch_vccz wcd_45
    s_cmp_lt_u32 s74, 40000
    s_cbranch_scc1 wc_44
    s_mov_b32 s73, 1
wcd_45:
    s_waitcnt vmcnt(7)
    s_add_u32 s76, s77, 114688
    buffer_load_dwordx4 a[12:15], v1, s[92:95], s76 offen
    s_add_u32 s91, s77, s58
    buffer_load_dwordx4 v[176:179], v1, s[20:23], s91 offen sc1
    s_add_u32 s76, s77, 121856
    buffer_load_dwordx4 a[40:43], v1, s[92:95], s76 offen
    s_add_u32 s91, s77, s58
    s_add_u32 s91, s91, 7168
    buffer_load_dwordx4 v[180:183], v1, s[20:23], s91 offen sc1
    v_mfma_f32_32x32x16_bf16 v[48:63], a[160:163], v[148:151], v[48:63]
    v_mfma_f32_32x32x16_bf16 v[64:79], a[32:35], v[148:151], v[64:79]
    s_waitcnt vmcnt(10)
    s_add_u32 s76, s77, 129024
    buffer_load_dwordx4 a[68:71], v1, s[92:95], s76 offen
    s_add_u32 s91, s77, s58
    s_add_u32 s91, s91, 14336
    buffer_load_dwordx4 v[184:187], v1, s[20:23], s91 offen sc1
    s_add_u32 s76, s77, 136192
    buffer_load_dwordx4 a[96:99], v1, s[92:95], s76 offen
    s_add_u32 s91, s77, s58
    s_add_u32 s91, s91, 21504
    buffer_load_dwordx4 v[188:191], v1, s[20:23], s91 offen sc1
    v_mfma_f32_32x32x16_bf16 v[48:63], a[188:191], v[152:155], v[48:63]
    v_mfma_f32_32x32x16_bf16 v[64:79], a[60:63], v[152:155], v[64:79]
    s_waitcnt vmcnt(13)
    s_add_u32 s76, s81, 114688
    buffer_load_dwordx4 a[16:19], v1, s[92:95], s76 offen
    s_add_u32 s91, s81, s58
    buffer_load_dwordx4 v[80:83], v1, s[20:23], s91 offen sc1
    s_add_u32 s76, s81, 121856
    buffer_load_dwordx4 a[44:47], v1, s[92:95], s76 offen
    s_add_u32 s91, s81, s58
    s_add_u32 s91, s91, 7168
    buffer_load_dwordx4 v[84:87], v1, s[20:23], s91 offen sc1
    v_mfma_f32_32x32x16_bf16 v[48:63], a[216:219], v[156:159], v[48:63]
    v_mfma_f32_32x32x16_bf16 v[64:79], a[88:91], v[156:159], v[64:79]
    s_waitcnt vmcnt(16)
    s_add_u32 s76, s81, 129024
    buffer_load_dwordx4 a[72:75], v1, s[92:95], s76 offen
    s_add_u32 s91, s81, s58
    s_add_u32 s91, s91, 14336
    buffer_load_dwordx4 v[88:91], v1, s[20:23], s91 offen sc1
    s_add_u32 s76, s81, 136192
    buffer_load_dwordx4 a[100:103], v1, s[92:95], s76 offen
    s_add_u32 s91, s81, s58
    s_add_u32 s91, s91, 21504
    buffer_load_dwordx4 v[92:95], v1, s[20:23], s91 offen sc1
    v_mfma_f32_32x32x16_bf16 v[48:63], a[136:139], v[160:163], v[48:63]
    v_mfma_f32_32x32x16_bf16 v[64:79], a[8:11], v[160:163], v[64:79]
    s_waitcnt vmcnt(19)
    s_add_u32 s76, s98, 114688
    buffer_load_dwordx4 a[20:23], v1, s[92:95], s76 offen
    s_add_u32 s91, s98, s58
    buffer_load_dwordx4 v[96:99], v1, s[20:23], s91 offen sc1
    s_add_u32 s76, s98, 121856
    buffer_load_dwordx4 a[48:51], v1, s[92:95], s76 offen
    s_add_u32 s91, s98, s58
    s_add_u32 s91, s91, 7168
    buffer_load_dwordx4 v[100:103], v1, s[20:23], s91 offen sc1
    v_mfma_f32_32x32x16_bf16 v[48:63], a[164:167], v[164:167], v[48:63]
    v_mfma_f32_32x32x16_bf16 v[64:79], a[36:39], v[164:167], v[64:79]
    s_waitcnt vmcnt(22)
    s_add_u32 s76, s98, 129024
    buffer_load_dwordx4 a[76:79], v1, s[92:95], s76 offen
    s_add_u32 s91, s98, s58
    s_add_u32 s91, s91, 14336
    buffer_load_dwordx4 v[104:107], v1, s[20:23], s91 offen sc1
    s_add_u32 s76, s98, 136192
    buffer_load_dwordx4 a[104:107], v1, s[92:95], s76 offen
    s_add_u32 s91, s98, s58
    s_add_u32 s91, s91, 21504
    buffer_load_dwordx4 v[108:111], v1, s[20:23], s91 offen sc1
    v_mfma_f32_32x32x16_bf16 v[48:63], a[192:195], v[168:171], v[48:63]
    v_mfma_f32_32x32x16_bf16 v[64:79], a[64:67], v[168:171], v[64:79]
    s_waitcnt vmcnt(25)
    s_add_u32 s76, s99, 114688
    buffer_load_dwordx4 a[24:27], v1, s[92:95], s76 offen
    s_add_u32 s91, s99, s58
    buffer_load_dwordx4 v[112:115], v1, s[20:23], s91 offen sc1
    s_add_u32 s76, s99, 121856
    buffer_load_dwordx4 a[52:55], v1, s[92:95], s76 offen
    s_add_u32 s91, s99, s58
    s_add_u32 s91, s91, 7168
    buffer_load_dwordx4 v[116:119], v1, s[20:23], s91 offen sc1
    v_mfma_f32_32x32x16_bf16 v[48:63], a[220:223], v[172:175], v[48:63]
    v_mfma_f32_32x32x16_bf16 v[64:79], a[92:95], v[172:175], v[64:79]
    s_waitcnt vmcnt(26)
    s_add_u32 s76, s99, 129024
    buffer_load_dwordx4 a[80:83], v1, s[92:95], s76 offen
    s_add_u32 s91, s99, s58
    s_add_u32 s91, s91, 14336
    buffer_load_dwordx4 v[120:123], v1, s[20:23], s91 offen sc1
    v_mfma_f32_32x32x16_bf16 v[16:31], a[140:143], v[176:179], v[16:31]
    v_mfma_f32_32x32x16_bf16 v[32:47], a[12:15], v[176:179], v[32:47]
    s_waitcnt vmcnt(26)
    s_add_u32 s76, s99, 136192
    buffer_load_dwordx4 a[108:111], v1, s[92:95], s76 offen
    s_add_u32 s91, s99, s58
    s_add_u32 s91, s91, 21504
    buffer_load_dwordx4 v[124:127], v1, s[20:23], s91 offen sc1
    v_mfma_f32_32x32x16_bf16 v[16:31], a[168:171], v[180:183], v[16:31]
    v_mfma_f32_32x32x16_bf16 v[32:47], a[40:43], v[180:183], v[32:47]
    s_waitcnt vmcnt(26)
    s_add_u32 s91, s77, s59
    buffer_load_dwordx4 v[128:131], v1, s[20:23], s91 offen sc1
    v_mfma_f32_32x32x16_bf16 v[16:31], a[196:199], v[184:187], v[16:31]
    v_mfma_f32_32x32x16_bf16 v[32:47], a[68:71], v[184:187], v[32:47]
    s_waitcnt vmcnt(25)
    s_add_u32 s91, s77, s59
    s_add_u32 s91, s91, 7168
    buffer_load_dwordx4 v[132:135], v1, s[20:23], s91 offen sc1
    v_mfma_f32_32x32x16_bf16 v[16:31], a[224:227], v[188:191], v[16:31]
    v_mfma_f32_32x32x16_bf16 v[32:47], a[96:99], v[188:191], v[32:47]
    s_waitcnt vmcnt(24)
    s_add_u32 s91, s77, s59
    s_add_u32 s91, s91, 14336
    buffer_load_dwordx4 v[136:139], v1, s[20:23], s91 offen sc1
    v_mfma_f32_32x32x16_bf16 v[16:31], a[144:147], v[80:83], v[16:31]
    v_mfma_f32_32x32x16_bf16 v[32:47], a[16:19], v[80:83], v[32:47]
    s_waitcnt vmcnt(23)
    s_add_u32 s91, s77, s59
    s_add_u32 s91, s91, 21504
    buffer_load_dwordx4 v[140:143], v1, s[20:23], s91 offen sc1
    v_mfma_f32_32x32x16_bf16 v[16:31], a[172:175], v[84:87], v[16:31]
    v_mfma_f32_32x32x16_bf16 v[32:47], a[44:47], v[84:87], v[32:47]
    s_waitcnt vmcnt(22)
    s_add_u32 s91, s81, s59
    buffer_load_dwordx4 v[144:147], v1, s[20:23], s91 offen sc1
    v_mfma_f32_32x32x16_bf16 v[16:31], a[200:203], v[88:91], v[16:31]
    v_mfma_f32_32x32x16_bf16 v[32:47], a[72:75], v[88:91], v[32:47]
    s_waitcnt vmcnt(21)
    s_add_u32 s91, s81, s59
    s_add_u32 s91, s91, 7168
    buffer_load_dwordx4 v[148:151], v1, s[20:23], s91 offen sc1
    v_mfma_f32_32x32x16_bf16 v[16:31], a[228:231], v[92:95], v[16:31]
    v_mfma_f32_32x32x16_bf16 v[32:47], a[100:103], v[92:95], v[32:47]
    s_waitcnt vmcnt(20)
    s_add_u32 s91, s81, s59
    s_add_u32 s91, s91, 14336
    buffer_load_dwordx4 v[152:155], v1, s[20:23], s91 offen sc1
    v_mfma_f32_32x32x16_bf16 v[16:31], a[148:151], v[96:99], v[16:31]
    v_mfma_f32_32x32x16_bf16 v[32:47], a[20:23], v[96:99], v[32:47]
    s_waitcnt vmcnt(19)
    s_add_u32 s91, s81, s59
    s_add_u32 s91, s91, 21504
    buffer_load_dwordx4 v[156:159], v1, s[20:23], s91 offen sc1
    v_mfma_f32_32x32x16_bf16 v[16:31], a[176:179], v[100:103], v[16:31]
    v_mfma_f32_32x32x16_bf16 v[32:47], a[48:51], v[100:103], v[32:47]
    s_waitcnt vmcnt(18)
    s_add_u32 s91, s98, s59
    buffer_load_dwordx4 v[160:163], v1, s[20:23], s91 offen sc1
    v_mfma_f32_32x32x16_bf16 v[16:31], a[204:207], v[104:107], v[16:31]
    v_mfma_f32_32x32x16_bf16 v[32:47], a[76:79], v[104:107], v[32:47]
    s_waitcnt vmcnt(17)
    s_add_u32 s91, s98, s59
    s_add_u32 s91, s91, 7168
    buffer_load_dwordx4 v[164:167], v1, s[20:23], s91 offen sc1
    v_mfma_f32_32x32x16_bf16 v[16:31], a[232:235], v[108:111], v[16:31]
    v_mfma_f32_32x32x16_bf16 v[32:47], a[104:107], v[108:111], v[32:47]
    s_waitcnt vmcnt(16)
    s_add_u32 s91, s98, s59
    s_add_u32 s91, s91, 14336
    buffer_load_dwordx4 v[168:171], v1, s[20:23], s91 offen sc1
    v_mfma_f32_32x32x16_bf16 v[16:31], a[152:155], v[112:115], v[16:31]
    v_mfma_f32_32x32x16_bf16 v[32:47], a[24:27], v[112:115], v[32:47]
    s_waitcnt vmcnt(15)
    s_add_u32 s91, s98, s59
    s_add_u32 s91, s91, 21504
    buffer_load_dwordx4 v[172:175], v1, s[20:23], s91 offen sc1
    v_mfma_f32_32x32x16_bf16 v[16:31], a[180:183], v[116:119], v[16:31]
    v_mfma_f32_32x32x16_bf16 v[32:47], a[52:55], v[116:119], v[32:47]
    s_waitcnt vmcnt(14)
    s_add_u32 s91, s99, s59
    buffer_load_dwordx4 v[176:179], v1, s[20:23], s91 offen sc1
    v_mfma_f32_32x32x16_bf16 v[16:31], a[208:211], v[120:123], v[16:31]
    v_mfma_f32_32x32x16_bf16 v[32:47], a[80:83], v[120:123], v[32:47]
    s_waitcnt vmcnt(13)
    s_add_u32 s91, s99, s59
    s_add_u32 s91, s91, 7168
    buffer_load_dwordx4 v[180:183], v1, s[20:23], s91 offen sc1
    v_mfma_f32_32x32x16_bf16 v[16:31], a[236:239], v[124:127], v[16:31]
    v_mfma_f32_32x32x16_bf16 v[32:47], a[108:111], v[124:127], v[32:47]
    s_waitcnt vmcnt(13)
    s_add_u32 s91, s99, s59
    s_add_u32 s91, s91, 14336
    buffer_load_dwordx4 v[184:187], v1, s[20:23], s91 offen sc1
    v_mfma_f32_32x32x16_bf16 v[48:63], a[140:143], v[128:131], v[48:63]
    v_mfma_f32_32x32x16_bf16 v[64:79], a[12:15], v[128:131], v[64:79]
    s_nop 9
    ds_write_b128 v220, v[16:19] offset:0
    ds_write_b128 v220, v[20:23] offset:1024
    ds_write_b128 v220, v[32:35] offset:2048
    ds_write_b128 v220, v[36:39] offset:3072
    ds_write_b128 v220, v[24:27] offset:4096
    ds_write_b128 v220, v[28:31] offset:5120
    s_waitcnt vmcnt(13)
    s_add_u32 s91, s99, s59
    s_add_u32 s91, s91, 21504
    buffer_load_dwordx4 v[188:191], v1, s[20:23], s91 offen sc1
    s_add_u32 m0, s33, 8192
    s_movk_i32 s32, 0
    buffer_load_dwordx4 v200, s[16:19], s32 offen lds
    s_add_u32 m0, s33, 9216
    s_movk_i32 s32, 0
    buffer_load_dwordx4 v201, s[16:19], s32 offen lds
    v_mfma_f32_32x32x16_bf16 v[48:63], a[168:171], v[132:135], v[48:63]
    v_mfma_f32_32x32x16_bf16 v[64:79], a[40:43], v[132:135], v[64:79]
    ds_write_b128 v220, v[40:43] offset:6144
    ds_write_b128 v220, v[44:47] offset:7168
    s_waitcnt lgkmcnt(0)
    s_barrier
    ds_read_b128 v[80:83], v222 offset:0
    ds_read_b128 v[84:87], v222 offset:1024
    ds_read_b128 v[88:91], v222 offset:16384
    ds_read_b128 v[92:95], v222 offset:17408
    ds_read_b128 v[96:99], v222 offset:32768
    ds_read_b128 v[100:103], v222 offset:33792
    s_waitcnt vmcnt(15)
    s_add_u32 m0, s33, 24576
    s_movk_i32 s32, 128
    buffer_load_dwordx4 v200, s[16:19], s32 offen lds
    s_add_u32 m0, s33, 25600
    s_movk_i32 s32, 128
    buffer_load_dwordx4 v201, s[16:19], s32 offen lds
    v_mfma_f32_32x32x16_bf16 v[48:63], a[196:199], v[136:139], v[48:63]
    v_mfma_f32_32x32x16_bf16 v[64:79], a[68:71], v[136:139], v[64:79]
    ds_read_b128 v[104:107], v222 offset:49152
    ds_read_b128 v[108:111], v222 offset:50176
    v_permlane32_swap_b32 v192, v194
    v_permlane32_swap_b32 v193, v195
    v_lshlrev_b32 v202, 16, v192
    v_and_b32 v203, 0xffff0000, v192
    v_lshlrev_b32 v204, 16, v193
    v_and_b32 v205, 0xffff0000, v193
    v_lshlrev_b32 v206, 16, v194
    v_and_b32 v207, 0xffff0000, v194
    v_lshlrev_b32 v208, 16, v195
    v_and_b32 v209, 0xffff0000, v195
    s_waitcnt vmcnt(16)
    s_add_u32 m0, s33, 40960
    s_movk_i32 s32, 256
    buffer_load_dwordx4 v200, s[16:19], s32 offen lds
    s_add_u32 m0, s33, 41984
    s_movk_i32 s32, 256
    buffer_load_dwordx4 v201, s[16:19], s32 offen lds
    v_mfma_f32_32x32x16_bf16 v[48:63], a[224:227], v[140:143], v[48:63]
    v_mfma_f32_32x32x16_bf16 v[64:79], a[96:99], v[140:143], v[64:79]
    s_waitcnt lgkmcnt(0)
    v_add_f32 v80, v80, v88
    v_add_f32 v81, v81, v89
    v_add_f32 v82, v82, v90
    v_add_f32 v83, v83, v91
    v_add_f32 v84, v84, v92
    v_add_f32 v85, v85, v93
    v_add_f32 v86, v86, v94
    v_add_f32 v87, v87, v95
    v_add_f32 v96, v96, v104
    v_add_f32 v97, v97, v105
    v_add_f32 v98, v98, v106
    s_waitcnt vmcnt(17)
    s_add_u32 m0, s33, 57344
    s_movk_i32 s32, 384
    buffer_load_dwordx4 v200, s[16:19], s32 offen lds
    s_add_u32 m0, s33, 58368
    s_movk_i32 s32, 384
    buffer_load_dwordx4 v201, s[16:19], s32 offen lds
    v_mfma_f32_32x32x16_bf16 v[48:63], a[144:147], v[144:147], v[48:63]
    v_mfma_f32_32x32x16_bf16 v[64:79], a[16:19], v[144:147], v[64:79]
    v_add_f32 v99, v99, v107
    v_add_f32 v100, v100, v108
    v_add_f32 v101, v101, v109
    v_add_f32 v102, v102, v110
    v_add_f32 v103, v103, v111
    v_add_f32 v202, v202, v80
    v_add_f32 v203, v203, v81
    v_add_f32 v204, v204, v82
    v_add_f32 v205, v205, v83
    v_add_f32 v206, v206, v84
    v_add_f32 v207, v207, v85
    v_add_f32 v208, v208, v86
    s_waitcnt vmcnt(18)
    s_add_u32 m0, s33, 73728
    s_movk_i32 s32, 512
    buffer_load_dwordx4 v200, s[16:19], s32 offen lds
    s_add_u32 m0, s33, 74752
    s_movk_i32 s32, 512
    buffer_load_dwordx4 v201, s[16:19], s32 offen lds
    v_mfma_f32_32x32x16_bf16 v[48:63], a[172:175], v[148:151], v[48:63]
    v_mfma_f32_32x32x16_bf16 v[64:79], a[44:47], v[148:151], v[64:79]
    v_add_f32 v209, v209, v87
    v_add_f32 v202, v202, v96
    v_add_f32 v203, v203, v97
    v_add_f32 v204, v204, v98
    v_add_f32 v205, v205, v99
    v_add_f32 v206, v206, v100
    v_add_f32 v207, v207, v101
    v_add_f32 v208, v208, v102
    v_add_f32 v209, v209, v103
    v_cvt_pk_bf16_f32 v210, v202, v203
    v_cvt_pk_bf16_f32 v211, v204, v205
    v_cvt_pk_bf16_f32 v212, v206, v207
    s_waitcnt vmcnt(19)
    s_add_u32 m0, s33, 90112
    s_movk_i32 s32, 640
    buffer_load_dwordx4 v200, s[16:19], s32 offen lds
    s_add_u32 m0, s33, 91136
    s_movk_i32 s32, 640
    buffer_load_dwordx4 v201, s[16:19], s32 offen lds
    v_mfma_f32_32x32x16_bf16 v[48:63], a[200:203], v[152:155], v[48:63]
    v_mfma_f32_32x32x16_bf16 v[64:79], a[72:75], v[152:155], v[64:79]
    v_cvt_pk_bf16_f32 v213, v208, v209
    v_add_f32 v214, v202, v203
    v_mul_f32 v215, v202, v202
    v_permlane32_swap_b32 v210, v212
    v_permlane32_swap_b32 v211, v213
    v_fma_f32 v215, v203, v203, v215
    buffer_store_dwordx4 v[210:213], v8, s[24:27], 0 offen sc1
    v_add_f32 v214, v214, v204
    v_fma_f32 v215, v204, v204, v215
    v_add_f32 v214, v214, v205
    v_fma_f32 v215, v205, v205, v215
    v_add_f32 v214, v214, v206
    s_waitcnt vmcnt(21)
    s_add_u32 m0, s33, 106496
    s_movk_i32 s32, 768
    buffer_load_dwordx4 v200, s[16:19], s32 offen lds
    s_add_u32 m0, s33, 107520
    s_movk_i32 s32, 768
    buffer_load_dwordx4 v201, s[16:19], s32 offen lds
    v_mfma_f32_32x32x16_bf16 v[48:63], a[228:231], v[156:159], v[48:63]
    v_mfma_f32_32x32x16_bf16 v[64:79], a[100:103], v[156:159], v[64:79]
    v_fma_f32 v215, v206, v206, v215
    v_add_f32 v214, v214, v207
    v_fma_f32 v215, v207, v207, v215
    v_add_f32 v214, v214, v208
    v_fma_f32 v215, v208, v208, v215
    v_add_f32 v214, v214, v209
    v_fma_f32 v215, v209, v209, v215
    v_mov_b32 v216, v214
    v_mov_b32 v217, v215
    s_nop 1
    v_permlane32_swap_b32 v214, v216
    s_waitcnt vmcnt(22)
    s_add_u32 m0, s33, 122880
    s_movk_i32 s32, 896
    buffer_load_dwordx4 v200, s[16:19], s32 offen lds
    s_add_u32 m0, s33, 123904
    s_movk_i32 s32, 896
    buffer_load_dwordx4 v201, s[16:19], s32 offen lds
    v_mfma_f32_32x32x16_bf16 v[48:63], a[148:151], v[160:163], v[48:63]
    v_mfma_f32_32x32x16_bf16 v[64:79], a[20:23], v[160:163], v[64:79]
    v_permlane32_swap_b32 v215, v217
    s_nop 0
    v_add_f32 v218, v214, v216
    v_add_f32 v219, v215, v217
    s_mov_b64 exec, 0xffffffff
    buffer_store_dwordx2 v[218:219], v10, s[28:31], 0 offen sc1
    s_mov_b64 exec, -1
    s_waitcnt vmcnt(24)
    v_mfma_f32_32x32x16_bf16 v[48:63], a[176:179], v[164:167], v[48:63]
    v_mfma_f32_32x32x16_bf16 v[64:79], a[48:51], v[164:167], v[64:79]
    s_waitcnt vmcnt(23)
    v_mfma_f32_32x32x16_bf16 v[48:63], a[204:207], v[168:171], v[48:63]
    v_mfma_f32_32x32x16_bf16 v[64:79], a[76:79], v[168:171], v[64:79]
    s_waitcnt vmcnt(22)
    v_mfma_f32_32x32x16_bf16 v[48:63], a[232:235], v[172:175], v[48:63]
    v_mfma_f32_32x32x16_bf16 v[64:79], a[104:107], v[172:175], v[64:79]
    s_waitcnt vmcnt(21)
    v_mfma_f32_32x32x16_bf16 v[48:63], a[152:155], v[176:179], v[48:63]
    v_mfma_f32_32x32x16_bf16 v[64:79], a[24:27], v[176:179], v[64:79]
    s_waitcnt vmcnt(20)
    v_mfma_f32_32x32x16_bf16 v[48:63], a[180:183], v[180:183], v[48:63]
    v_mfma_f32_32x32x16_bf16 v[64:79], a[52:55], v[180:183], v[64:79]
    s_waitcnt vmcnt(19)
    v_mfma_f32_32x32x16_bf16 v[48:63], a[208:211], v[184:187], v[48:63]
    v_mfma_f32_32x32x16_bf16 v[64:79], a[80:83], v[184:187], v[64:79]
    s_waitcnt vmcnt(18)
    v_mfma_f32_32x32x16_bf16 v[48:63], a[236:239], v[188:191], v[48:63]
    v_mfma_f32_32x32x16_bf16 v[64:79], a[108:111], v[188:191], v[64:79]
    s_nop 11
    ds_write_b128 v221, v[48:51] offset:0
    ds_write_b128 v221, v[52:55] offset:1024
    ds_write_b128 v221, v[64:67] offset:2048
    ds_write_b128 v221, v[68:71] offset:3072
    ds_write_b128 v221, v[56:59] offset:4096
    ds_write_b128 v221, v[60:63] offset:5120
    ds_write_b128 v221, v[72:75] offset:6144
    ds_write_b128 v221, v[76:79] offset:7168
    s_waitcnt lgkmcnt(0)
    s_barrier
    ds_read_b128 v[80:83], v223 offset:0
    ds_read_b128 v[84:87], v223 offset:1024
    ds_read_b128 v[88:91], v223 offset:16384
    ds_read_b128 v[92:95], v223 offset:17408
    ds_read_b128 v[96:99], v223 offset:32768
    ds_read_b128 v[100:103], v223 offset:33792
    ds_read_b128 v[104:107], v223 offset:49152
    ds_read_b128 v[108:111], v223 offset:50176
    v_permlane32_swap_b32 v196, v198
    v_permlane32_swap_b32 v197, v199
    v_lshlrev_b32 v202, 16, v196
    v_and_b32 v203, 0xffff0000, v196
    v_lshlrev_b32 v204, 16, v197
    v_and_b32 v205, 0xffff0000, v197
    v_lshlrev_b32 v206, 16, v198
    v_and_b32 v207, 0xffff0000, v198
    v_lshlrev_b32 v208, 16, v199
    v_and_b32 v209, 0xffff0000, v199
    s_waitcnt lgkmcnt(0)
    v_add_f32 v80, v80, v88
    v_add_f32 v81, v81, v89
    v_add_f32 v82, v82, v90
    v_add_f32 v83, v83, v91
    v_add_f32 v84, v84, v92
    v_add_f32 v85, v85, v93
    v_add_f32 v86, v86, v94
    v_add_f32 v87, v87, v95
    v_add_f32 v96, v96, v104
    v_add_f32 v97, v97, v105
    v_add_f32 v98, v98, v106
    v_add_f32 v99, v99, v107
    v_add_f32 v100, v100, v108
    v_add_f32 v101, v101, v109
    v_add_f32 v102, v102, v110
    v_add_f32 v103, v103, v111
    v_add_f32 v202, v202, v80
    v_add_f32 v203, v203, v81
    v_add_f32 v204, v204, v82
    v_add_f32 v205, v205, v83
    v_add_f32 v206, v206, v84
    v_add_f32 v207, v207, v85
    v_add_f32 v208, v208, v86
    v_add_f32 v209, v209, v87
    v_add_f32 v202, v202, v96
    v_add_f32 v203, v203, v97
    v_add_f32 v204, v204, v98
    v_add_f32 v205, v205, v99
    v_add_f32 v206, v206, v100
    v_add_f32 v207, v207, v101
    v_add_f32 v208, v208, v102
    v_add_f32 v209, v209, v103
    v_cvt_pk_bf16_f32 v210, v202, v203
    v_cvt_pk_bf16_f32 v211, v204, v205
    v_cvt_pk_bf16_f32 v212, v206, v207
    v_cvt_pk_bf16_f32 v213, v208, v209
    v_add_f32 v214, v202, v203
    v_mul_f32 v215, v202, v202
    v_permlane32_swap_b32 v210, v212
    v_permlane32_swap_b32 v211, v213
    v_fma_f32 v215, v203, v203, v215
    buffer_store_dwordx4 v[210:213], v9, s[24:27], 0 offen sc1
    v_add_f32 v214, v214, v204
    s_branch warm_over_3
warm_stub_3:
    s_branch warm_ret
warm_over_3:
    v_fma_f32 v215, v204, v204, v215
    v_add_f32 v214, v214, v205
    v_fma_f32 v215, v205, v205, v215
    v_add_f32 v214, v214, v206
    v_fma_f32 v215, v206, v206, v215
    v_add_f32 v214, v214, v207
    v_fma_f32 v215, v207, v207, v215
    v_add_f32 v214, v214, v208
    v_fma_f32 v215, v208, v208, v215
    v_add_f32 v214, v214, v209
    v_fma_f32 v215, v209, v209, v215
    v_mov_b32 v216, v214
    v_mov_b32 v217, v215
    s_nop 1
    v_permlane32_swap_b32 v214, v216
    v_permlane32_swap_b32 v215, v217
    s_nop 0
    v_add_f32 v218, v214, v216
    v_add_f32 v219, v215, v217
    s_mov_b64 exec, 0xffffffff
    buffer_store_dwordx2 v[218:219], v11, s[28:31], 0 offen sc1
    s_mov_b64 exec, -1
    s_lshl_b32 s54, s11, 2
    s_add_u32 s54, s54, s14
    s_lshl_b32 s54, s54, 7
    s_add_u32 s54, s54, s46
    v_mov_b32 v4, s54
    s_cmp_lg_u32 s72, 0
    s_cbranch_scc1 k_done
    s_waitcnt vmcnt(0)
    s_barrier
    s_cmp_lg_u32 s10, 0
    s_cbranch_scc1 sig_46
    s_mov_b64 exec, 1
    v_mov_b32 v2, 1
    global_atomic_add v4, v2, s[4:5] sc1
    s_mov_b64 exec, -1
sig_46:
    s_and_b32 s13, s12, 7
    s_lshr_b32 s14, s12, 3
    s_and_b32 s50, s10, 1
    s_lshr_b32 s51, s10, 1
    v_lshrrev_b32 v2, 3, v0
    v_and_b32 v3, 7, v0
    s_lshl_b32 s54, s14, 1
    s_add_u32 s54, s54, s50
    s_lshl_b32 s57, s51, 11
    v_add_u32 v8, s57, v1
    v_add_u32 v9, s57, v1
    v_add_u32 v9, 1024, v9
    s_lshl_b32 s55, s11, 3
    s_add_u32 s55, s55, s54
    s_lshl_b32 s55, s55, 15
    s_add_u32 s55, s55, 0x200000
    s_add_u32 s20, s4, s55
    s_addc_u32 s21, s5, 0
    s_mov_b32 s22, 0x8000
    s_mov_b32 s23, 0x20000
    s_lshl_b32 s34, s50, 12
    s_lshl_b32 s55, s51, 11
    s_add_u32 s34, s34, s55
    v_and_b32 v2, 15, v0
    v_lshrrev_b32 v3, 4, v0
    v_lshrrev_b32 v4, 1, v2
    s_lshl_b32 s52, s51, 2
    v_add_u32 v5, s52, v3
    v_xor_b32 v6, v5, v4
    v_lshlrev_b32 v6, 4, v6
    v_lshl_add_u32 v6, v2, 7, v6
    v_xor_b32 v7, 64, v6
    s_lshl_b32 s53, s51, 12
    s_add_u32 s53, s53, 8192
    v_add_u32 v18, s53, v6
    v_add_u32 v19, s53, v7
    s_lshl_b32 s53, s50, 12
    v_lshlrev_b32 v26, 9, v5
    v_lshl_add_u32 v26, v2, 4, v26
    v_xor_b32 v27, 2048, v26
    s_add_u32 s54, s53, 0
    v_add_u32 v10, s54, v26
    v_add_u32 v11, s54, v27
    s_add_u32 s54, s53, 256
    v_add_u32 v12, s54, v26
    v_add_u32 v13, s54, v27
    v_add_u32 v14, 0x10000, v10
    v_add_u32 v15, 0x10000, v11
    v_add_u32 v16, 0x10000, v12
    v_add_u32 v17, 0x10000, v13
    v_add_u32 v20, 0x10000, v18
    v_add_u32 v21, 0x10000, v19
    s_lshl_b32 s54, s11, 2
    s_add_u32 s54, s54, s14
    s_lshl_b32 s54, s54, 10
    s_lshl_b32 s55, s50, 9
    s_add_u32 s54, s54, s55
    s_lshl_b32 s55, s13, 15
    s_lshl_b32 s56, s51, 8
    s_add_u32 s55, s55, s56
    s_add_u32 s55, s55, s54
    v_lshlrev_b32 v4, 4, v2
    v_lshlrev_b32 v6, 19, v3
    v_add_u32 v22, s55, v4
    v_add_u32 v22, v22, v6
    s_sub_u32 s55, 15, s13
    s_lshl_b32 s55, s55, 15
    s_add_u32 s55, s55, s54
    s_add_u32 s55, s55, 496
    s_sub_u32 s55, s55, s56
    v_sub_u32 v5, s55, v4
    v_sub_u32 v4, 8, v3
    v_and_b32 v4, 7, v4
    v_lshlrev_b32 v4, 19, v4
    v_add_u32 v23, v5, v4
    v_sub_u32 v4, 4, v3
    v_lshlrev_b32 v4, 19, v4
    v_add_u32 v27, v5, v4
    v_mov_b32 v92, 0
    v_mov_b32 v93, 0
    v_mov_b32 v94, 0
    v_mov_b32 v95, 0
    v_mov_b32 v96, 0
    v_mov_b32 v97, 0
    v_mov_b32 v98, 0
    v_mov_b32 v99, 0
    v_mov_b32 v100, 0
    v_mov_b32 v101, 0
    v_mov_b32 v102, 0
    v_mov_b32 v103, 0
    v_mov_b32 v104, 0
    v_mov_b32 v105, 0
    v_mov_b32 v106, 0
    v_mov_b32 v107, 0
    v_mov_b32 v108, 0
    v_mov_b32 v109, 0
    v_mov_b32 v110, 0
    v_mov_b32 v111, 0
    s_mov_b32 s75, 0x3f803f80
    s_lshl_b32 s54, s50, 9
    s_add_u32 s54, s54, 131072
    v_and_b32 v4, 31, v0
    s_lshl_b32 s55, s51, 3
    s_add_u32 s55, s55, s54
    v_lshlrev_b32 v24, 4, v4
    v_add_u32 v24, s55, v24
    v_lshlrev_b32 v25, 6, v3
    v_add_u32 v25, s54, v25
    s_lshl_b32 s54, s11, 2
    s_add_u32 s54, s54, s14
    s_lshl_b32 s54, s54, 7
    s_add_u32 s54, s54, 0x2506000
    v_mov_b32 v4, s54
    v_mov_b32 v5, 8
    s_lshl_b32 s54, s11, 3
    s_lshl_b32 s55, s14, 1
    s_add_u32 s54, s54, s55
    s_add_u32 s54, s54, s50
    s_lshl_b32 s54, s54, 13
    s_lshl_b32 s55, s51, 12
    s_add_u32 s54, s54, s55
    v_and_b32 v6, 31, v0
    v_lshrrev_b32 v7, 5, v0
    v_lshlrev_b32 v7, 11, v7
    v_lshl_add_u32 v7, v6, 3, v7
    v_add_u32 v7, s54, v7
    s_add_u32 s24, s4, 0x2700000
    s_addc_u32 s25, s5, 0
    s_mov_b32 s26, 0x80000
    s_mov_b32 s27, 0x20000
    s_cmp_lg_u32 s10, 0
    s_cbranch_scc1 polls_49
    s_cmp_lg_u32 s73, 0
    s_cbranch_scc1 polls_49
    s_mov_b64 exec, 0x1
    s_mov_b32 s74, 0
poll_47:
    global_load_dword v2, v4, s[4:5] sc1
    s_add_u32 s74, s74, 1
    s_waitcnt vmcnt(0)
    v_cmp_gt_u32 vcc, v5, v2
    s_cbranch_vccz polld_48
    s_cmp_lt_u32 s74, 40000
    s_cbranch_scc1 poll_47
    s_mov_b32 s73, 1
polld_48:
    s_mov_b64 exec, -1
polls_49:
    s_barrier
    s_add_u32 m0, s34, 0
    s_movk_i32 s32, 0
    buffer_load_dwordx4 v8, s[20:23], s32 offen sc1 lds
    s_add_u32 m0, s34, 1024
    s_movk_i32 s32, 0
    buffer_load_dwordx4 v9, s[20:23], s32 offen sc1 lds
    s_add_u32 m0, s34, 16384
    s_movk_i32 s32, 4096
    buffer_load_dwordx4 v8, s[20:23], s32 offen sc1 lds
    s_add_u32 m0, s34, 17408
    s_movk_i32 s32, 4096
    buffer_load_dwordx4 v9, s[20:23], s32 offen sc1 lds
    s_add_u32 m0, s34, 32768
    s_movk_i32 s32, 8192
    buffer_load_dwordx4 v8, s[20:23], s32 offen sc1 lds
    s_add_u32 m0, s34, 33792
    s_movk_i32 s32, 8192
    buffer_load_dwordx4 v9, s[20:23], s32 offen sc1 lds
    s_add_u32 m0, s34, 49152
    s_movk_i32 s32, 12288
    buffer_load_dwordx4 v8, s[20:23], s32 offen sc1 lds
    s_add_u32 m0, s34, 50176
    s_movk_i32 s32, 12288
    buffer_load_dwordx4 v9, s[20:23], s32 offen sc1 lds
    s_add_u32 s28, s4, 0xa00000
    s_addc_u32 s29, s5, 0
    s_mov_b32 s30, 0x400000
    s_mov_b32 s31, 0x20000
    s_waitcnt vmcnt(6)
    s_barrier
    s_add_u32 m0, s34, 65536
    s_movk_i32 s32, 16384
    buffer_load_dwordx4 v8, s[20:23], s32 offen sc1 lds
    s_add_u32 m0, s34, 66560
    s_movk_i32 s32, 16384
    buffer_load_dwordx4 v9, s[20:23], s32 offen sc1 lds
    s_add_u32 m0, s34, 81920
    s_movk_i32 s32, 20480
    buffer_load_dwordx4 v8, s[20:23], s32 offen sc1 lds
    s_add_u32 m0, s34, 82944
    s_movk_i32 s32, 20480
    buffer_load_dwordx4 v9, s[20:23], s32 offen sc1 lds
    ds_read_b128 v[28:31], v10 offset:0
    ds_read_b128 v[32:35], v12 offset:0
    ds_read_b128 v[44:47], v18 offset:0
    ds_read_b128 v[48:51], v18 offset:2048
    ds_read_b128 v[36:39], v11 offset:0
    ds_read_b128 v[40:43], v13 offset:0
    ds_read_b128 v[52:55], v19 offset:0
    ds_read_b128 v[56:59], v19 offset:2048
    s_waitcnt vmcnt(8)
    s_barrier
    s_waitcnt lgkmcnt(0)
    s_add_u32 m0, s34, 98304
    s_movk_i32 s32, 24576
    buffer_load_dwordx4 v8, s[20:23], s32 offen sc1 lds
    s_add_u32 m0, s34, 99328
    s_movk_i32 s32, 24576
    buffer_load_dwordx4 v9, s[20:23], s32 offen sc1 lds
    s_add_u32 m0, s34, 114688
    s_movk_i32 s32, 28672
    buffer_load_dwordx4 v8, s[20:23], s32 offen sc1 lds
    s_add_u32 m0, s34, 115712
    s_movk_i32 s32, 28672
    buffer_load_dwordx4 v9, s[20:23], s32 offen sc1 lds
    ds_read_b128 v[60:63], v10 offset:16384
    v_mfma_f32_16x16x32_bf16 v[92:95], v[28:31], v[44:47], v[92:95]
    ds_read_b128 v[64:67], v12 offset:16384
    v_mfma_f32_16x16x32_bf16 v[96:99], v[32:35], v[44:47], v[96:99]
    ds_read_b128 v[76:79], v18 offset:16384
    v_mfma_f32_16x16x32_bf16 v[100:103], v[28:31], v[48:51], v[100:103]
    ds_read_b128 v[80:83], v18 offset:18432
    v_mfma_f32_16x16x32_bf16 v[104:107], v[32:35], v[48:51], v[104:107]
    ds_read_b128 v[68:71], v11 offset:16384
    v_mfma_f32_16x16x32_bf16 v[92:95], v[36:39], v[52:55], v[92:95]
    ds_read_b128 v[72:75], v13 offset:16384
    v_mfma_f32_16x16x32_bf16 v[96:99], v[40:43], v[52:55], v[96:99]
    ds_read_b128 v[84:87], v19 offset:16384
    v_mfma_f32_16x16x32_bf16 v[100:103], v[36:39], v[56:59], v[100:103]
    ds_read_b128 v[88:91], v19 offset:18432
    v_mfma_f32_16x16x32_bf16 v[104:107], v[40:43], v[56:59], v[104:107]
    s_waitcnt vmcnt(10)
    s_barrier
    s_waitcnt lgkmcnt(0)
    buffer_load_dwordx2 v[136:137], v7, s[24:27], 0 offen offset:0 sc1
    buffer_load_dwordx2 v[138:139], v7, s[24:27], 0 offen offset:256 sc1
    buffer_load_dwordx2 v[140:141], v7, s[24:27], 0 offen offset:512 sc1
    buffer_load_dwordx2 v[142:143], v7, s[24:27], 0 offen offset:768 sc1
    buffer_load_dwordx2 v[144:145], v7, s[24:27], 0 offen offset:1024 sc1
    buffer_load_dwordx2 v[146:147], v7, s[24:27], 0 offen offset:1280 sc1
    buffer_load_dwordx2 v[148:149], v7, s[24:27], 0 offen offset:1536 sc1
    buffer_load_dwordx2 v[150:151], v7, s[24:27], 0 offen offset:1792 sc1
    ds_read_b128 v[28:31], v10 offset:32768
    v_mfma_f32_16x16x32_bf16 v[92:95], v[60:63], v[76:79], v[92:95]
    ds_read_b128 v[32:35], v12 offset:32768
    v_mfma_f32_16x16x32_bf16 v[96:99], v[64:67], v[76:79], v[96:99]
    ds_read_b128 v[44:47], v18 offset:32768
    v_mfma_f32_16x16x32_bf16 v[100:103], v[60:63], v[80:83], v[100:103]
    ds_read_b128 v[48:51], v18 offset:34816
    v_mfma_f32_16x16x32_bf16 v[104:107], v[64:67], v[80:83], v[104:107]
    ds_read_b128 v[36:39], v11 offset:32768
    v_mfma_f32_16x16x32_bf16 v[92:95], v[68:71], v[84:87], v[92:95]
    ds_read_b128 v[40:43], v13 offset:32768
    v_mfma_f32_16x16x32_bf16 v[96:99], v[72:75], v[84:87], v[96:99]
    ds_read_b128 v[52:55], v19 offset:32768
    v_mfma_f32_16x16x32_bf16 v[100:103], v[68:71], v[88:91], v[100:103]
    ds_read_b128 v[56:59], v19 offset:34816
    v_mfma_f32_16x16x32_bf16 v[104:107], v[72:75], v[88:91], v[104:107]
    s_waitcnt vmcnt(16)
    s_barrier
    s_waitcnt lgkmcnt(0)
    ds_read_b128 v[60:63], v10 offset:49152
    v_mfma_f32_16x16x32_bf16 v[92:95], v[28:31], v[44:47], v[92:95]
    ds_read_b128 v[64:67], v12 offset:49152
    v_mfma_f32_16x16x32_bf16 v[96:99], v[32:35], v[44:47], v[96:99]
    ds_read_b128 v[76:79], v18 offset:49152
    v_mfma_f32_16x16x32_bf16 v[100:103], v[28:31], v[48:51], v[100:103]
    ds_read_b128 v[80:83], v18 offset:51200
    v_mfma_f32_16x16x32_bf16 v[104:107], v[32:35], v[48:51], v[104:107]
    ds_read_b128 v[68:71], v11 offset:49152
    v_mfma_f32_16x16x32_bf16 v[92:95], v[36:39], v[52:55], v[92:95]
    ds_read_b128 v[72:75], v13 offset:49152
    v_mfma_f32_16x16x32_bf16 v[96:99], v[40:43], v[52:55], v[96:99]
    ds_read_b128 v[84:87], v19 offset:49152
    v_mfma_f32_16x16x32_bf16 v[100:103], v[36:39], v[56:59], v[100:103]
    ds_read_b128 v[88:91], v19 offset:51200
    v_mfma_f32_16x16x32_bf16 v[104:107], v[40:43], v[56:59], v[104:107]
    s_waitcnt vmcnt(14)
    s_barrier
    s_waitcnt lgkmcnt(0)
    ds_read_b128 v[28:31], v14 offset:0
    v_mfma_f32_16x16x32_bf16 v[92:95], v[60:63], v[76:79], v[92:95]
    ds_read_b128 v[32:35], v16 offset:0
    v_mfma_f32_16x16x32_bf16 v[96:99], v[64:67], v[76:79], v[96:99]
    ds_read_b128 v[44:47], v20 offset:0
    v_mfma_f32_16x16x32_bf16 v[100:103], v[60:63], v[80:83], v[100:103]
    ds_read_b128 v[48:51], v20 offset:2048
    v_mfma_f32_16x16x32_bf16 v[104:107], v[64:67], v[80:83], v[104:107]
    ds_read_b128 v[36:39], v15 offset:0
    v_mfma_f32_16x16x32_bf16 v[92:95], v[68:71], v[84:87], v[92:95]
    ds_read_b128 v[40:43], v17 offset:0
    v_mfma_f32_16x16x32_bf16 v[96:99], v[72:75], v[84:87], v[96:99]
    ds_read_b128 v[52:55], v21 offset:0
    v_mfma_f32_16x16x32_bf16 v[100:103], v[68:71], v[88:91], v[100:103]
    ds_read_b128 v[56:59], v21 offset:2048
    v_mfma_f32_16x16x32_bf16 v[104:107], v[72:75], v[88:91], v[104:107]
    s_waitcnt vmcnt(12)
    s_barrier
    s_waitcnt lgkmcnt(0)
    ds_read_b128 v[60:63], v14 offset:16384
    v_mfma_f32_16x16x32_bf16 v[92:95], v[28:31], v[44:47], v[92:95]
    ds_read_b128 v[64:67], v16 offset:16384
    v_mfma_f32_16x16x32_bf16 v[96:99], v[32:35], v[44:47], v[96:99]
    ds_read_b128 v[76:79], v20 offset:16384
    v_mfma_f32_16x16x32_bf16 v[100:103], v[28:31], v[48:51], v[100:103]
    ds_read_b128 v[80:83], v20 offset:18432
    v_mfma_f32_16x16x32_bf16 v[104:107], v[32:35], v[48:51], v[104:107]
    ds_read_b128 v[68:71], v15 offset:16384
    v_mfma_f32_16x16x32_bf16 v[92:95], v[36:39], v[52:55], v[92:95]
    ds_read_b128 v[72:75], v17 offset:16384
    v_mfma_f32_16x16x32_bf16 v[96:99], v[40:43], v[52:55], v[96:99]
    ds_read_b128 v[84:87], v21 offset:16384
    v_mfma_f32_16x16x32_bf16 v[100:103], v[36:39], v[56:59], v[100:103]
    ds_read_b128 v[88:91], v21 offset:18432
    v_mfma_f32_16x16x32_bf16 v[104:107], v[40:43], v[56:59], v[104:107]
    s_waitcnt vmcnt(10)
    s_barrier
    s_waitcnt lgkmcnt(0)
    ds_read_b128 v[28:31], v14 offset:32768
    v_mfma_f32_16x16x32_bf16 v[92:95], v[60:63], v[76:79], v[92:95]
    ds_read_b128 v[32:35], v16 offset:32768
    v_mfma_f32_16x16x32_bf16 v[96:99], v[64:67], v[76:79], v[96:99]
    ds_read_b128 v[44:47], v20 offset:32768
    v_mfma_f32_16x16x32_bf16 v[100:103], v[60:63], v[80:83], v[100:103]
    ds_read_b128 v[48:51], v20 offset:34816
    v_mfma_f32_16x16x32_bf16 v[104:107], v[64:67], v[80:83], v[104:107]
    ds_read_b128 v[36:39], v15 offset:32768
    v_mfma_f32_16x16x32_bf16 v[92:95], v[68:71], v[84:87], v[92:95]
    ds_read_b128 v[40:43], v17 offset:32768
    v_mfma_f32_16x16x32_bf16 v[96:99], v[72:75], v[84:87], v[96:99]
    ds_read_b128 v[52:55], v21 offset:32768
    v_mfma_f32_16x16x32_bf16 v[100:103], v[68:71], v[88:91], v[100:103]
    ds_read_b128 v[56:59], v21 offset:34816
    v_mfma_f32_16x16x32_bf16 v[104:107], v[72:75], v[88:91], v[104:107]
    s_waitcnt vmcnt(0)
    v_pk_add_f32 v[136:137], v[136:137], v[144:145]
    v_pk_add_f32 v[138:139], v[138:139], v[146:147]
    v_pk_add_f32 v[140:141], v[140:141], v[148:149]
    v_pk_add_f32 v[142:143], v[142:143], v[150:151]
    v_pk_add_f32 v[136:137], v[136:137], v[140:141]
    v_pk_add_f32 v[138:139], v[138:139], v[142:143]
    v_pk_add_f32 v[136:137], v[136:137], v[138:139]
    v_mov_b32 v138, v136
    v_mov_b32 v139, v137
    s_nop 1
    v_permlane32_swap_b32 v136, v138
    v_permlane32_swap_b32 v137, v139
    s_nop 0
    v_pk_add_f32 v[136:137], v[136:137], v[138:139]
    s_mov_b64 exec, 0xffffffff
    ds_write_b64 v24, v[136:137]
    s_mov_b64 exec, -1
    s_waitcnt lgkmcnt(0)
    s_waitcnt vmcnt(8)
    s_barrier
    s_waitcnt lgkmcnt(0)
    ds_read_b128 v[60:63], v14 offset:49152
    v_mfma_f32_16x16x32_bf16 v[92:95], v[28:31], v[44:47], v[92:95]
    ds_read_b128 v[64:67], v16 offset:49152
    v_mfma_f32_16x16x32_bf16 v[96:99], v[32:35], v[44:47], v[96:99]
    ds_read_b128 v[76:79], v20 offset:49152
    v_mfma_f32_16x16x32_bf16 v[100:103], v[28:31], v[48:51], v[100:103]
    ds_read_b128 v[80:83], v20 offset:51200
    v_mfma_f32_16x16x32_bf16 v[104:107], v[32:35], v[48:51], v[104:107]
    ds_read_b128 v[68:71], v15 offset:49152
    v_mfma_f32_16x16x32_bf16 v[92:95], v[36:39], v[52:55], v[92:95]
    ds_read_b128 v[72:75], v17 offset:49152
    v_mfma_f32_16x16x32_bf16 v[96:99], v[40:43], v[52:55], v[96:99]
    ds_read_b128 v[84:87], v21 offset:49152
    v_mfma_f32_16x16x32_bf16 v[100:103], v[36:39], v[56:59], v[100:103]
    ds_read_b128 v[88:91], v21 offset:51200
    v_mfma_f32_16x16x32_bf16 v[104:107], v[40:43], v[56:59], v[104:107]
    s_waitcnt lgkmcnt(0)
    v_mfma_f32_16x16x32_bf16 v[92:95], v[60:63], v[76:79], v[92:95]
    v_mfma_f32_16x16x32_bf16 v[96:99], v[64:67], v[76:79], v[96:99]
    v_mfma_f32_16x16x32_bf16 v[100:103], v[60:63], v[80:83], v[100:103]
    v_mfma_f32_16x16x32_bf16 v[104:107], v[64:67], v[80:83], v[104:107]
    v_mfma_f32_16x16x32_bf16 v[92:95], v[68:71], v[84:87], v[92:95]
    v_mfma_f32_16x16x32_bf16 v[96:99], v[72:75], v[84:87], v[96:99]
    v_mfma_f32_16x16x32_bf16 v[100:103], v[68:71], v[88:91], v[100:103]
    v_mfma_f32_16x16x32_bf16 v[104:107], v[72:75], v[88:91], v[104:107]
    s_barrier
    ds_read_b128 v[152:155], v25 offset:0
    ds_read_b128 v[156:159], v25 offset:16
    ds_read_b128 v[160:163], v25 offset:32
    ds_read_b128 v[164:167], v25 offset:48
    ds_read_b128 v[168:171], v25 offset:256
    ds_read_b128 v[172:175], v25 offset:272
    ds_read_b128 v[176:179], v25 offset:288
    ds_read_b128 v[180:183], v25 offset:304
    s_waitcnt lgkmcnt(0)
    s_mov_b32 s78, 0x3b000000
    s_mov_b32 s79, 0x3b000000
    v_pk_add_f32 v[152:153], v[152:153], v[154:155]
    v_pk_add_f32 v[156:157], v[156:157], v[158:159]
    v_pk_add_f32 v[160:161], v[160:161], v[162:163]
    v_pk_add_f32 v[164:165], v[164:165], v[166:167]
    v_pk_add_f32 v[168:169], v[168:169], v[170:171]
    v_pk_add_f32 v[172:173], v[172:173], v[174:175]
    v_pk_add_f32 v[176:177], v[176:177], v[178:179]
    v_pk_add_f32 v[180:181], v[180:181], v[182:183]
    v_pk_mul_f32 v[152:153], v[152:153], s[78:79]
    v_pk_mul_f32 v[156:157], v[156:157], s[78:79]
    v_pk_mul_f32 v[160:161], v[160:161], s[78:79]
    v_pk_mul_f32 v[164:165], v[164:165], s[78:79]
    v_pk_mul_f32 v[168:169], v[168:169], s[78:79]
    v_pk_mul_f32 v[172:173], v[172:173], s[78:79]
    v_pk_mul_f32 v[176:177], v[176:177], s[78:79]
    v_pk_mul_f32 v[180:181], v[180:181], s[78:79]
    v_fma_f32 v153, -v152, v152, v153
    v_fma_f32 v157, -v156, v156, v157
    v_fma_f32 v161, -v160, v160, v161
    v_fma_f32 v165, -v164, v164, v165
    v_fma_f32 v169, -v168, v168, v169
    v_fma_f32 v173, -v172, v172, v173
    v_fma_f32 v177, -v176, v176, v177
    v_fma_f32 v181, -v180, v180, v181
    v_add_f32 v153, 0x3727c5ac, v153
    v_add_f32 v157, 0x3727c5ac, v157
    v_add_f32 v161, 0x3727c5ac, v161
    v_add_f32 v165, 0x3727c5ac, v165
    v_add_f32 v169, 0x3727c5ac, v169
    v_add_f32 v173, 0x3727c5ac, v173
    v_add_f32 v177, 0x3727c5ac, v177
    v_add_f32 v181, 0x3727c5ac, v181
    v_rsq_f32 v112, v153
    v_rsq_f32 v113, v157
    v_rsq_f32 v114, v161
    v_rsq_f32 v115, v165
    v_rsq_f32 v116, v169
    v_rsq_f32 v117, v173
    v_rsq_f32 v118, v177
    v_rsq_f32 v119, v181
    s_nop 0
    v_pk_mul_f32 v[92:93], v[92:93], v[112:113]
    v_pk_mul_f32 v[94:95], v[94:95], v[114:115]
    v_pk_mul_f32 v[96:97], v[96:97], v[116:117]
    v_pk_mul_f32 v[98:99], v[98:99], v[118:119]
    v_pk_mul_f32 v[100:101], v[100:101], v[112:113]
    v_pk_mul_f32 v[102:103], v[102:103], v[114:115]
    v_pk_mul_f32 v[104:105], v[104:105], v[116:117]
    v_pk_mul_f32 v[106:107], v[106:107], v[118:119]
    v_pk_add_f32 v[28:29], v[92:93], v[96:97]
    v_pk_add_f32 v[36:37], v[92:93], v[96:97] neg_lo:[0,1] neg_hi:[0,1]
    v_pk_add_f32 v[32:33], v[100:101], v[104:105]
    v_pk_add_f32 v[40:41], v[100:101], v[104:105] neg_lo:[0,1] neg_hi:[0,1]
    v_pk_add_f32 v[30:31], v[94:95], v[98:99]
    v_pk_add_f32 v[38:39], v[94:95], v[98:99] neg_lo:[0,1] neg_hi:[0,1]
    v_pk_add_f32 v[34:35], v[102:103], v[106:107]
    v_pk_add_f32 v[42:43], v[102:103], v[106:107] neg_lo:[0,1] neg_hi:[0,1]
    v_pk_add_f32 v[44:45], v[28:29], v[30:31]
    v_pk_add_f32 v[46:47], v[32:33], v[34:35]
    v_pk_add_f32 v[48:49], v[28:29], v[30:31] neg_lo:[0,1] neg_hi:[0,1]
    v_pk_add_f32 v[50:51], v[32:33], v[34:35] neg_lo:[0,1] neg_hi:[0,1]
    v_add_f32 v60, v44, v45
    v_add_f32 v68, v46, v47
    v_sub_f32 v64, v44, v45
    v_sub_f32 v72, v46, v47
    v_add_f32 v62, v48, v51
    v_sub_f32 v70, v50, v49
    v_sub_f32 v66, v48, v51
    v_add_f32 v74, v50, v49
    v_add_f32 v52, v36, v42
    v_sub_f32 v53, v40, v38
    v_sub_f32 v54, v36, v42
    v_add_f32 v55, v40, v38
    v_sub_f32 v56, v37, v39
    v_add_f32 v57, v41, v43
    v_add_f32 v58, v37, v39
    v_sub_f32 v59, v41, v43
    v_add_f32 v76, v56, v57
    v_sub_f32 v77, v59, v58
    v_add_f32 v78, v58, v59
    v_sub_f32 v79, v57, v56
    s_mov_b32 s75, 0x3f3504f3
    v_fma_f32 v61, s75, v76, v52
    v_fma_f32 v65, -s75, v76, v52
    v_fma_f32 v69, s75, v77, v53
    v_fma_f32 v73, -s75, v77, v53
    v_fma_f32 v63, s75, v79, v54
    v_fma_f32 v67, -s75, v79, v54
    v_fma_f32 v71, -s75, v78, v55
    v_fma_f32 v75, s75, v78, v55
    v_cvt_pk_bf16_f32 v80, v60, v68
    v_cvt_pk_bf16_f32 v81, v61, v69
    v_cvt_pk_bf16_f32 v82, v62, v70
    v_cvt_pk_bf16_f32 v83, v63, v71
    v_cvt_pk_bf16_f32 v84, v64, v72
    v_cvt_pk_bf16_f32 v85, v65, v73
    v_cvt_pk_bf16_f32 v86, v66, v74
    v_cvt_pk_bf16_f32 v87, v67, v75
    v_mov_b32 v76, 0x80000000
    v_xor_b32 v88, v76, v80
    v_xor_b32 v89, v76, v81
    v_xor_b32 v90, v76, v82
    v_xor_b32 v91, v76, v83
    v_xor_b32 v92, v76, v84
    v_xor_b32 v93, v76, v85
    v_xor_b32 v94, v76, v86
    v_xor_b32 v95, v76, v87
    s_nop 0
    v_permlane32_swap_b32 v80, v82
    v_permlane32_swap_b32 v81, v83
    v_permlane32_swap_b32 v84, v86
    v_permlane32_swap_b32 v85, v87
    v_permlane32_swap_b32 v88, v90
    v_permlane32_swap_b32 v89, v91
    v_permlane32_swap_b32 v92, v94
    v_permlane32_swap_b32 v93, v95
    v_permlane16_swap_b32 v80, v81
    v_permlane16_swap_b32 v82, v83
    v_permlane16_swap_b32 v84, v85
    v_permlane16_swap_b32 v86, v87
    v_permlane16_swap_b32 v88, v89
    v_permlane16_swap_b32 v90, v91
    v_permlane16_swap_b32 v92, v93
    v_permlane16_swap_b32 v94, v95
    s_mov_b32 s54, 0x200000
    buffer_store_dwordx4 v[80:83], v22, s[28:31], 0 offen sc1
    buffer_store_dwordx4 v[84:87], v22, s[28:31], s54 offen sc1
    buffer_store_dwordx4 v[88:91], v23, s[28:31], 0 offen sc1
    buffer_store_dwordx4 v[92:95], v27, s[28:31], 0 offen sc1
    s_lshr_b32 s34, s12, 3
    s_lshl_b32 s34, s34, 1
    s_lshl_b32 s35, s11, 3
    s_add_u32 s34, s34, s35
    s_and_b32 s35, s10, 1
    s_add_u32 s34, s34, s35
    s_lshl_b32 s34, s34, 15
    s_add_u32 s34, s34, 0xe00000
    s_add_u32 s16, s4, s34
    s_addc_u32 s17, s5, 0
    s_mov_b32 s18, 0x8000
    s_mov_b32 s19, 0x20000
    s_lshl_b32 s34, s35, 12
    s_lshr_b32 s35, s10, 1
    s_lshl_b32 s35, s35, 11
    s_add_u32 s34, s34, s35
    s_add_u32 m0, s34, 8192
    s_add_u32 s32, s35, 0
    buffer_load_dwordx4 v1, s[16:19], s32 offen offset:0 lds
    buffer_load_dwordx4 v1, s[16:19], s32 offen offset:1024 lds
    s_add_u32 m0, s34, 24576
    s_add_u32 s32, s35, 4096
    buffer_load_dwordx4 v1, s[16:19], s32 offen offset:0 lds
    buffer_load_dwordx4 v1, s[16:19], s32 offen offset:1024 lds
    s_add_u32 m0, s34, 40960
    s_add_u32 s32, s35, 8192
    buffer_load_dwordx4 v1, s[16:19], s32 offen offset:0 lds
    buffer_load_dwordx4 v1, s[16:19], s32 offen offset:1024 lds
    s_add_u32 m0, s34, 57344
    s_add_u32 s32, s35, 12288
    buffer_load_dwordx4 v1, s[16:19], s32 offen offset:0 lds
    buffer_load_dwordx4 v1, s[16:19], s32 offen offset:1024 lds
    s_lshr_b32 s54, s13, 1
    v_and_b32 v5, 3, v0
    v_mov_b32 v4, s54
    s_sub_u32 s55, 7, s54
    v_mov_b32 v6, s55
    v_cmp_eq_u32 vcc, 1, v5
    s_nop 1
    v_cndmask_b32 v4, v4, v6, vcc
    s_add_u32 s55, s54, 1
    v_mov_b32 v6, s55
    v_cmp_eq_u32 vcc, 2, v5
    s_nop 1
    v_cndmask_b32 v4, v4, v6, vcc
    v_lshrrev_b32 v6, 2, v0
    v_lshl_add_u32 v4, v6, 3, v4
    v_lshlrev_b32 v4, 3, v4
    v_add_u32 v4, s11, v4
    v_lshlrev_b32 v4, 7, v4
    v_add_u32 v4, 0x251a000, v4
    s_and_b32 s56, s13, 1
    s_cmp_eq_u32 s13, 7
    s_cselect_b32 s56, 0, s56
    s_lshl_b32 s56, s56, 2
    s_or_b32 s56, s56, 3
    s_mul_i32 s56, s56, 0x11111111
    s_mov_b32 s57, 0
    s_waitcnt vmcnt(8)
    s_barrier
    s_cmp_lg_u32 s10, 0
    s_cbranch_scc1 sig_50
    s_mov_b64 exec, s[56:57]
    v_mov_b32 v2, 1
    global_atomic_add v4, v2, s[4:5] sc1
    s_mov_b64 exec, -1
sig_50:
    s_mov_b32 s72, 1
    s_branch layer_loop
k_done:
k_exit:
    s_endpgm
k_end:
.section .rodata,"a"
.p2align 6
.amdhsa_kernel interleave_layers__spectral_fnet__swiglu_ffn__prompt_kernel
  .amdhsa_next_free_vgpr 512
  .amdhsa_next_free_sgpr 102
  .amdhsa_accum_offset 256
  .amdhsa_group_segment_fixed_size 0
  .amdhsa_kernarg_size 96
  .amdhsa_user_sgpr_count 2
  .amdhsa_user_sgpr_kernarg_segment_ptr 1
  .amdhsa_system_sgpr_workgroup_id_x 1
  .amdhsa_float_denorm_mode_32 3
  .amdhsa_float_denorm_mode_16_64 3
.end_amdhsa_kernel
```
